```python
import torch

def _softmax(x, axis=-1):
    return torch.softmax(x, dim=axis)
def _gelu(x):
    return torch.nn.functional.gelu(x, approximate="tanh")
def _silu(x):
    return torch.nn.functional.silu(x)
def _sigmoid(x):
    return torch.sigmoid(x)
def _layernorm(x, axis=-1, eps=1e-5):
    m = x.mean(dim=axis, keepdim=True)
    v = x.var(dim=axis, keepdim=True, unbiased=False)
    return (x - m) / torch.sqrt(v + eps)
def _scatter_add(tgt, idx, src, axis=0):
    return tgt.clone().index_add_(axis, idx, src)
def _segment_sum(src, seg, n):
    out = torch.zeros((n,) + src.shape[1:], dtype=src.dtype)
    return out.index_add_(0, seg, src)
def _pad(x, pw):
    flat = tuple(v for pair in reversed(pw) for v in pair)
    return torch.nn.functional.pad(x, flat)

kernel_name = 'concat_heads__softmax_full_mha__linear_attn_block__prompt'

def setup_inputs():

    _w = (lambda a: (lambda t: t.to(torch.bfloat16) if t.is_floating_point() else t)(torch.as_tensor(a)))
    def _A_setup():
        B, S, D = 1, 2048, 448
        return {
            "x": _w((lambda *s: torch.randn(*s, dtype=torch.bfloat16) * 0.2)(B, S, D)),
            "wqkv": _w((lambda *s: torch.randn(*s, dtype=torch.bfloat16) * 0.2)(D, 3 * D)),
            "wo": _w((lambda *s: torch.randn(*s, dtype=torch.bfloat16) * 0.05)(D, D)),
        }
    _A_in = _A_setup()

    def _B_setup():
        B, S, D = 1, 2048, 448
        return {
            "x": _w((lambda *s: torch.randn(*s, dtype=torch.bfloat16) * 0.05)(B, S, D)),
            "wqkv": _w((lambda *s: torch.randn(*s, dtype=torch.bfloat16) * 1.6)(D, 3 * D)),
            "wo": _w((lambda *s: torch.randn(*s, dtype=torch.bfloat16) * 0.05)(D, D)),
        }
    _B_in = _B_setup()

    return {
        "A_x": _A_in["x"],
        "A_wqkv": _A_in["wqkv"],
        "A_wo": _A_in["wo"],
        "B_x": _B_in["x"],
        "B_wqkv": _B_in["wqkv"],
        "B_wo": _B_in["wo"],
    }

def reference(A_x, A_wqkv, A_wo, B_x, B_wqkv, B_wo):
    def _A_ref(x, wqkv, wo):
        B, S, D = x.shape
        H = 16; Dh = D // H
        qkv = (lambda x, *d: x.permute(*d))((x @ wqkv).reshape(B, S, 3, H, Dh), 2, 0, 3, 1, 4)
        q, k, v = qkv[0], qkv[1], qkv[2]
        scale = Dh ** -0.5
        scores = torch.einsum("bhqd,bhkd->bhqk", q, k) * scale
        p = _softmax(scores, axis=-1)
        o = torch.einsum("bhqk,bhkd->bhqd", p, v)
        return (lambda x, *d: x.permute(*d))(o, 0, 2, 1, 3).reshape(B, S, D) @ wo

    def _B_ref(x, wqkv, wo):
        B, S, D = x.shape
        H = 16; Dh = D // H
        qkv = (lambda x, *d: x.permute(*d))((x @ wqkv).reshape(B, S, 3, H, Dh), 2, 0, 3, 1, 4)
        q, k, v = qkv[0], qkv[1], qkv[2]
        phi = lambda t: torch.where(t > 0, t + 1, torch.exp(t)) + 1e-6
        pq, pk = phi(q), phi(k)
        kv = torch.einsum("bhsd,bhse->bhde", pk, v)
        z = torch.einsum("bhsd->bhd", pk)
        num = torch.einsum("bhqd,bhde->bhqe", pq, kv)
        den = torch.einsum("bhqd,bhd->bhq", pq, z)[..., None] + 1e-6
        o = num / den
        return (lambda x, *d: x.permute(*d))(o, 0, 2, 1, 3).reshape(B, S, D) @ wo

    a = _A_ref(A_x, A_wqkv, A_wo)
    b = _B_ref(B_x, B_wqkv, B_wo)
    return torch.concatenate([a, b], axis=-1)
```

```asm
; @launch grid=(256,1,1) block=(512,1,1) lds=163840
.amdgcn_target "amdgcn-amd-amdhsa--gfx950"
.text
.globl concat_heads__softmax_full_mha__linear_attn_block__prompt_kernel
.p2align 8
.type concat_heads__softmax_full_mha__linear_attn_block__prompt_kernel,@function
concat_heads__softmax_full_mha__linear_attn_block__prompt_kernel:
    s_cmp_ge_u32 s2, 256
    s_cbranch_scc1 L_END
    s_load_dwordx4 s[4:7], s[0:1], 0
    s_load_dwordx4 s[32:35], s[0:1], 24
    s_load_dwordx2 s[12:13], s[0:1], 64
    s_load_dwordx4 s[48:51], s[0:1], 48
    s_load_dwordx2 s[44:45], s[0:1], 16
    s_load_dwordx2 s[56:57], s[0:1], 40
    v_lshrrev_b32 v1, 6, v0
    v_and_b32 v2, 63, v0
    s_and_b32 s40, s2, 7
    s_lshr_b32 s41, s2, 3
    v_readfirstlane_b32 s19, v1
    s_lshr_b32 s16, s41, 4
    s_lshr_b32 s17, s40, 1
    s_bfe_u32 s42, s41, 0x20002
    s_lshl_b32 s17, s17, 2
    s_add_u32 s17, s17, s42
    s_and_b32 s18, s40, 1
    s_lshl_b32 s18, s18, 2
    s_and_b32 s20, s41, 3
    s_add_u32 s18, s18, s20
    s_lshl_b32 s22, s40, 1
    s_and_b32 s23, s41, 1
    s_add_u32 s22, s22, s23
    s_lshr_b32 s23, s41, 1
    s_cmp_eq_u32 s16, 0
    s_cselect_b32 s17, s22, s17
    s_cselect_b32 s18, s23, s18
    s_cselect_b32 s20, 0, s20
    s_and_b32 s38, s2, 15
    s_lshr_b32 s39, s2, 4
    s_mov_b32 s14, 16777216
    s_mov_b32 s15, 0x20000
    s_mov_b32 s54, 256
    s_mov_b32 s55, 0x20000
    v_mov_b32 v35, 163824
    s_lshr_b32 s29, s2, 4
    s_cmp_eq_u32 s29, 7
    s_cbranch_scc1 L_IDLE
L_ROLE:
    s_cmp_ge_u32 s19, 4
    s_cbranch_scc0 L_COMPUTE
L_LOADER:
    s_sub_u32 s21, s19, 4
    v_lshrrev_b32 v3, 3, v2
    v_and_b32 v4, 7, v2
    v_lshrrev_b32 v5, 4, v2
    v_xor_b32 v6, v4, v5
    v_mul_u32_u24 v7, 896, v3
    v_lshl_add_u32 v10, v6, 4, v7
    v_xor_b32 v11, 64, v10
    v_and_b32 v5, 1, v5
    v_lshlrev_b32 v5, 2, v5
    v_add_u32 v6, s20, v4
    v_sub_u32 v6, v6, v5
    v_and_b32 v6, 7, v6
    v_cmp_ne_u32 s[94:95], 7, v6
    v_mul_u32_u24 v9, 2688, v3
    v_lshl_add_u32 v12, v6, 4, v9
    s_cmp_eq_u32 s16, 0
    s_cselect_b64 s[94:95], -1, s[94:95]
    s_movk_i32 s26, 112
    s_cselect_b32 s26, 128, s26
    s_lshl_b32 s23, s42, 1
    s_add_u32 s23, s23, s18
    s_mul_i32 s23, s23, 0
    s_cmp_ge_u32 s23, 7
    s_cselect_b32 s24, 7, 0
    s_sub_u32 s23, s23, s24
    s_lshl_b32 s24, s17, 2
    s_add_u32 s24, s24, s21
    s_mul_i32 s24, s24, 28672
    s_mul_i32 s25, s21, 43008
    s_mul_i32 s26, s18, s26
    s_add_u32 s25, s25, s26
    s_lshl_b32 s36, s21, 12
    s_lshl_b32 s37, s21, 11
    s_add_u32 s37, s37, 16384
    s_waitcnt lgkmcnt(0)
    s_mov_b32 s52, s50
    s_mov_b32 s53, s51
    s_cmp_eq_u32 s16, 1
    s_cselect_b32 s4, s32, s4
    s_cselect_b32 s5, s33, s5
    s_cselect_b32 s8, s34, s6
    s_cselect_b32 s9, s35, s7
    s_mov_b32 s6, 1835008
    s_mov_b32 s7, 0x20000
    s_mov_b32 s10, 1204224
    s_mov_b32 s11, 0x20000
    s_lshl_b32 s29, s16, 3
    s_add_u32 s29, s29, s18
    s_cmp_eq_u32 s29, 7
    s_cbranch_scc1 L_NOLOAD
    s_lshl_b32 s26, s23, 7
    s_add_u32 s26, s26, s24
    s_mul_i32 s27, s23, 172032
    s_add_u32 s27, s27, s25
    s_add_u32 s23, s23, 1
    s_cmp_eq_u32 s23, 7
    s_cselect_b32 s23, 0, s23
    s_add_u32 m0, s36, 40960
    s_add_u32 s30, s26, 0
    buffer_load_dwordx4 v10, s[4:7], s30 offen sc1 lds
    s_add_u32 m0, s36, 41984
    s_add_u32 s30, s26, 7168
    buffer_load_dwordx4 v11, s[4:7], s30 offen sc1 lds
    s_add_u32 m0, s36, 43008
    s_add_u32 s30, s26, 14336
    buffer_load_dwordx4 v10, s[4:7], s30 offen sc1 lds
    s_add_u32 m0, s36, 44032
    s_add_u32 s30, s26, 21504
    buffer_load_dwordx4 v11, s[4:7], s30 offen sc1 lds
    s_mov_b64 exec, s[94:95]
    s_add_u32 m0, s37, 40960
    s_add_u32 s30, s27, 0
    buffer_load_dwordx4 v12, s[8:11], s30 offen sc1 lds
    s_add_u32 m0, s37, 41984
    s_add_u32 s30, s27, 21504
    buffer_load_dwordx4 v12, s[8:11], s30 offen sc1 lds
    s_add_u32 m0, s37, 49152
    s_add_u32 s30, s27, 896
    buffer_load_dwordx4 v12, s[8:11], s30 offen sc1 lds
    s_add_u32 m0, s37, 50176
    s_add_u32 s30, s27, 22400
    buffer_load_dwordx4 v12, s[8:11], s30 offen sc1 lds
    s_add_u32 m0, s37, 57344
    s_add_u32 s30, s27, 1792
    buffer_load_dwordx4 v12, s[8:11], s30 offen sc1 lds
    s_add_u32 m0, s37, 58368
    s_add_u32 s30, s27, 23296
    buffer_load_dwordx4 v12, s[8:11], s30 offen sc1 lds
    s_mov_b64 exec, -1
    s_lshl_b32 s26, s23, 7
    s_add_u32 s26, s26, s24
    s_mul_i32 s27, s23, 172032
    s_add_u32 s27, s27, s25
    s_add_u32 s23, s23, 1
    s_cmp_eq_u32 s23, 7
    s_cselect_b32 s23, 0, s23
    s_add_u32 m0, s36, 81920
    s_add_u32 s30, s26, 0
    buffer_load_dwordx4 v10, s[4:7], s30 offen sc1 lds
    s_add_u32 m0, s36, 82944
    s_add_u32 s30, s26, 7168
    buffer_load_dwordx4 v11, s[4:7], s30 offen sc1 lds
    s_add_u32 m0, s36, 83968
    s_add_u32 s30, s26, 14336
    buffer_load_dwordx4 v10, s[4:7], s30 offen sc1 lds
    s_add_u32 m0, s36, 84992
    s_add_u32 s30, s26, 21504
    buffer_load_dwordx4 v11, s[4:7], s30 offen sc1 lds
    s_mov_b64 exec, s[94:95]
    s_add_u32 m0, s37, 81920
    s_add_u32 s30, s27, 0
    buffer_load_dwordx4 v12, s[8:11], s30 offen sc1 lds
    s_add_u32 m0, s37, 82944
    s_add_u32 s30, s27, 21504
    buffer_load_dwordx4 v12, s[8:11], s30 offen sc1 lds
    s_add_u32 m0, s37, 90112
    s_add_u32 s30, s27, 896
    buffer_load_dwordx4 v12, s[8:11], s30 offen sc1 lds
    s_add_u32 m0, s37, 91136
    s_add_u32 s30, s27, 22400
    buffer_load_dwordx4 v12, s[8:11], s30 offen sc1 lds
    s_add_u32 m0, s37, 98304
    s_add_u32 s30, s27, 1792
    buffer_load_dwordx4 v12, s[8:11], s30 offen sc1 lds
    s_add_u32 m0, s37, 99328
    s_add_u32 s30, s27, 23296
    buffer_load_dwordx4 v12, s[8:11], s30 offen sc1 lds
    s_mov_b64 exec, -1
    s_waitcnt vmcnt(10)
    s_barrier
    s_lshl_b32 s26, s23, 7
    s_add_u32 s26, s26, s24
    s_mul_i32 s27, s23, 172032
    s_add_u32 s27, s27, s25
    s_add_u32 s23, s23, 1
    s_cmp_eq_u32 s23, 7
    s_cselect_b32 s23, 0, s23
    s_add_u32 m0, s36, 122880
    s_add_u32 s30, s26, 0
    buffer_load_dwordx4 v10, s[4:7], s30 offen sc1 lds
    s_add_u32 m0, s36, 123904
    s_add_u32 s30, s26, 7168
    buffer_load_dwordx4 v11, s[4:7], s30 offen sc1 lds
    s_add_u32 m0, s36, 124928
    s_add_u32 s30, s26, 14336
    buffer_load_dwordx4 v10, s[4:7], s30 offen sc1 lds
    s_add_u32 m0, s36, 125952
    s_add_u32 s30, s26, 21504
    buffer_load_dwordx4 v11, s[4:7], s30 offen sc1 lds
    s_mov_b64 exec, s[94:95]
    s_add_u32 m0, s37, 122880
    s_add_u32 s30, s27, 0
    buffer_load_dwordx4 v12, s[8:11], s30 offen sc1 lds
    s_add_u32 m0, s37, 123904
    s_add_u32 s30, s27, 21504
    buffer_load_dwordx4 v12, s[8:11], s30 offen sc1 lds
    s_add_u32 m0, s37, 131072
    s_add_u32 s30, s27, 896
    buffer_load_dwordx4 v12, s[8:11], s30 offen sc1 lds
    s_add_u32 m0, s37, 132096
    s_add_u32 s30, s27, 22400
    buffer_load_dwordx4 v12, s[8:11], s30 offen sc1 lds
    s_add_u32 m0, s37, 139264
    s_add_u32 s30, s27, 1792
    buffer_load_dwordx4 v12, s[8:11], s30 offen sc1 lds
    s_add_u32 m0, s37, 140288
    s_add_u32 s30, s27, 23296
    buffer_load_dwordx4 v12, s[8:11], s30 offen sc1 lds
    s_mov_b64 exec, -1
    s_waitcnt vmcnt(10)
    s_barrier
    s_lshl_b32 s26, s23, 7
    s_add_u32 s26, s26, s24
    s_mul_i32 s27, s23, 172032
    s_add_u32 s27, s27, s25
    s_add_u32 s23, s23, 1
    s_cmp_eq_u32 s23, 7
    s_cselect_b32 s23, 0, s23
    s_add_u32 m0, s36, 0
    s_add_u32 s30, s26, 0
    buffer_load_dwordx4 v10, s[4:7], s30 offen sc1 lds
    s_add_u32 m0, s36, 1024
    s_add_u32 s30, s26, 7168
    buffer_load_dwordx4 v11, s[4:7], s30 offen sc1 lds
    s_add_u32 m0, s36, 2048
    s_add_u32 s30, s26, 14336
    buffer_load_dwordx4 v10, s[4:7], s30 offen sc1 lds
    s_add_u32 m0, s36, 3072
    s_add_u32 s30, s26, 21504
    buffer_load_dwordx4 v11, s[4:7], s30 offen sc1 lds
    s_mov_b64 exec, s[94:95]
    s_add_u32 m0, s37, 0
    s_add_u32 s30, s27, 0
    buffer_load_dwordx4 v12, s[8:11], s30 offen sc1 lds
    s_add_u32 m0, s37, 1024
    s_add_u32 s30, s27, 21504
    buffer_load_dwordx4 v12, s[8:11], s30 offen sc1 lds
    s_add_u32 m0, s37, 8192
    s_add_u32 s30, s27, 896
    buffer_load_dwordx4 v12, s[8:11], s30 offen sc1 lds
    s_add_u32 m0, s37, 9216
    s_add_u32 s30, s27, 22400
    buffer_load_dwordx4 v12, s[8:11], s30 offen sc1 lds
    s_add_u32 m0, s37, 16384
    s_add_u32 s30, s27, 1792
    buffer_load_dwordx4 v12, s[8:11], s30 offen sc1 lds
    s_add_u32 m0, s37, 17408
    s_add_u32 s30, s27, 23296
    buffer_load_dwordx4 v12, s[8:11], s30 offen sc1 lds
    s_mov_b64 exec, -1
    s_waitcnt vmcnt(10)
    s_barrier
    s_lshl_b32 s26, s23, 7
    s_add_u32 s26, s26, s24
    s_mul_i32 s27, s23, 172032
    s_add_u32 s27, s27, s25
    s_add_u32 s23, s23, 1
    s_cmp_eq_u32 s23, 7
    s_cselect_b32 s23, 0, s23
    s_add_u32 m0, s36, 40960
    s_add_u32 s30, s26, 0
    buffer_load_dwordx4 v10, s[4:7], s30 offen sc1 lds
    s_add_u32 m0, s36, 41984
    s_add_u32 s30, s26, 7168
    buffer_load_dwordx4 v11, s[4:7], s30 offen sc1 lds
    s_add_u32 m0, s36, 43008
    s_add_u32 s30, s26, 14336
    buffer_load_dwordx4 v10, s[4:7], s30 offen sc1 lds
    s_add_u32 m0, s36, 44032
    s_add_u32 s30, s26, 21504
    buffer_load_dwordx4 v11, s[4:7], s30 offen sc1 lds
    s_mov_b64 exec, s[94:95]
    s_add_u32 m0, s37, 40960
    s_add_u32 s30, s27, 0
    buffer_load_dwordx4 v12, s[8:11], s30 offen sc1 lds
    s_add_u32 m0, s37, 41984
    s_add_u32 s30, s27, 21504
    buffer_load_dwordx4 v12, s[8:11], s30 offen sc1 lds
    s_add_u32 m0, s37, 49152
    s_add_u32 s30, s27, 896
    buffer_load_dwordx4 v12, s[8:11], s30 offen sc1 lds
    s_add_u32 m0, s37, 50176
    s_add_u32 s30, s27, 22400
    buffer_load_dwordx4 v12, s[8:11], s30 offen sc1 lds
    s_add_u32 m0, s37, 57344
    s_add_u32 s30, s27, 1792
    buffer_load_dwordx4 v12, s[8:11], s30 offen sc1 lds
    s_add_u32 m0, s37, 58368
    s_add_u32 s30, s27, 23296
    buffer_load_dwordx4 v12, s[8:11], s30 offen sc1 lds
    s_mov_b64 exec, -1
    s_waitcnt vmcnt(10)
    s_barrier
    s_lshl_b32 s26, s23, 7
    s_add_u32 s26, s26, s24
    s_mul_i32 s27, s23, 172032
    s_add_u32 s27, s27, s25
    s_add_u32 s23, s23, 1
    s_cmp_eq_u32 s23, 7
    s_cselect_b32 s23, 0, s23
    s_add_u32 m0, s36, 81920
    s_add_u32 s30, s26, 0
    buffer_load_dwordx4 v10, s[4:7], s30 offen sc1 lds
    s_add_u32 m0, s36, 82944
    s_add_u32 s30, s26, 7168
    buffer_load_dwordx4 v11, s[4:7], s30 offen sc1 lds
    s_add_u32 m0, s36, 83968
    s_add_u32 s30, s26, 14336
    buffer_load_dwordx4 v10, s[4:7], s30 offen sc1 lds
    s_add_u32 m0, s36, 84992
    s_add_u32 s30, s26, 21504
    buffer_load_dwordx4 v11, s[4:7], s30 offen sc1 lds
    s_mov_b64 exec, s[94:95]
    s_add_u32 m0, s37, 81920
    s_add_u32 s30, s27, 0
    buffer_load_dwordx4 v12, s[8:11], s30 offen sc1 lds
    s_add_u32 m0, s37, 82944
    s_add_u32 s30, s27, 21504
    buffer_load_dwordx4 v12, s[8:11], s30 offen sc1 lds
    s_add_u32 m0, s37, 90112
    s_add_u32 s30, s27, 896
    buffer_load_dwordx4 v12, s[8:11], s30 offen sc1 lds
    s_add_u32 m0, s37, 91136
    s_add_u32 s30, s27, 22400
    buffer_load_dwordx4 v12, s[8:11], s30 offen sc1 lds
    s_add_u32 m0, s37, 98304
    s_add_u32 s30, s27, 1792
    buffer_load_dwordx4 v12, s[8:11], s30 offen sc1 lds
    s_add_u32 m0, s37, 99328
    s_add_u32 s30, s27, 23296
    buffer_load_dwordx4 v12, s[8:11], s30 offen sc1 lds
    s_mov_b64 exec, -1
    s_waitcnt vmcnt(10)
    s_barrier
    s_lshl_b32 s26, s23, 7
    s_add_u32 s26, s26, s24
    s_mul_i32 s27, s23, 172032
    s_add_u32 s27, s27, s25
    s_add_u32 s23, s23, 1
    s_cmp_eq_u32 s23, 7
    s_cselect_b32 s23, 0, s23
    s_add_u32 m0, s36, 122880
    s_add_u32 s30, s26, 0
    buffer_load_dwordx4 v10, s[4:7], s30 offen sc1 lds
    s_add_u32 m0, s36, 123904
    s_add_u32 s30, s26, 7168
    buffer_load_dwordx4 v11, s[4:7], s30 offen sc1 lds
    s_add_u32 m0, s36, 124928
    s_add_u32 s30, s26, 14336
    buffer_load_dwordx4 v10, s[4:7], s30 offen sc1 lds
    s_add_u32 m0, s36, 125952
    s_add_u32 s30, s26, 21504
    buffer_load_dwordx4 v11, s[4:7], s30 offen sc1 lds
    s_mov_b64 exec, s[94:95]
    s_add_u32 m0, s37, 122880
    s_add_u32 s30, s27, 0
    buffer_load_dwordx4 v12, s[8:11], s30 offen sc1 lds
    s_add_u32 m0, s37, 123904
    s_add_u32 s30, s27, 21504
    buffer_load_dwordx4 v12, s[8:11], s30 offen sc1 lds
    s_add_u32 m0, s37, 131072
    s_add_u32 s30, s27, 896
    buffer_load_dwordx4 v12, s[8:11], s30 offen sc1 lds
    s_add_u32 m0, s37, 132096
    s_add_u32 s30, s27, 22400
    buffer_load_dwordx4 v12, s[8:11], s30 offen sc1 lds
    s_add_u32 m0, s37, 139264
    s_add_u32 s30, s27, 1792
    buffer_load_dwordx4 v12, s[8:11], s30 offen sc1 lds
    s_add_u32 m0, s37, 140288
    s_add_u32 s30, s27, 23296
    buffer_load_dwordx4 v12, s[8:11], s30 offen sc1 lds
    s_mov_b64 exec, -1
    s_waitcnt vmcnt(10)
    s_barrier
    s_waitcnt vmcnt(0)
    s_barrier
    s_barrier
    s_branch L_NOLOAD
L_COMPUTE:
    s_and_b32 s21, s19, 1
    s_lshr_b32 s22, s19, 1
    v_and_b32 v3, 31, v2
    v_lshrrev_b32 v4, 5, v2
    v_lshrrev_b32 v5, 1, v3
    v_and_b32 v5, 7, v5
    s_lshl_b32 s23, s21, 13
    v_lshlrev_b32 v6, 7, v3
    v_add_u32 v6, s23, v6
    v_add_u32 v7, 0, v4
    v_xor_b32 v7, v7, v5
    v_lshl_add_u32 v10, v7, 4, v6
    v_add_u32 v16, 81920, v10
    v_add_u32 v7, 2, v4
    v_xor_b32 v7, v7, v5
    v_lshl_add_u32 v11, v7, 4, v6
    v_add_u32 v17, 81920, v11
    v_add_u32 v7, 4, v4
    v_xor_b32 v7, v7, v5
    v_lshl_add_u32 v12, v7, 4, v6
    v_add_u32 v18, 81920, v12
    v_add_u32 v7, 6, v4
    v_xor_b32 v7, v7, v5
    v_lshl_add_u32 v13, v7, 4, v6
    v_add_u32 v19, 81920, v13
    v_lshrrev_b32 v5, 4, v2
    v_and_b32 v5, 1, v5
    v_and_b32 v6, 3, v2
    v_lshl_add_u32 v6, v5, 2, v6
    s_sub_u32 s23, 8, s16
    s_mul_i32 s23, s22, s23
    v_add_u32 v6, s23, v6
    v_lshrrev_b32 v7, 2, v2
    v_and_b32 v7, 3, v7
    v_lshrrev_b32 v8, 1, v6
    v_subrev_u32 v8, s20, v8
    v_lshrrev_b32 v9, 1, v7
    v_lshl_add_u32 v8, v9, 2, v8
    v_and_b32 v8, 7, v8
    v_and_b32 v6, 1, v6
    v_lshlrev_b32 v6, 3, v6
    v_lshl_add_u32 v6, v8, 4, v6
    v_lshl_add_u32 v7, v4, 3, v7
    v_lshl_add_u32 v6, v7, 7, v6
    v_add_u32 v14, 16384, v6
    v_add_u32 v15, 98304, v6
    v_lshlrev_b32 v1, 4, v2
    s_cmp_eq_u32 s16, 1
    s_cselect_b32 s23, 897988541, 0
    v_mov_b32 v160, s23
    v_mov_b32 v161, s23
    v_mov_b32 v162, s23
    v_mov_b32 v163, s23
    v_mov_b32 v164, s23
    v_mov_b32 v165, s23
    v_mov_b32 v166, s23
    v_mov_b32 v167, s23
    v_mov_b32 v168, s23
    v_mov_b32 v169, s23
    v_mov_b32 v170, s23
    v_mov_b32 v171, s23
    v_mov_b32 v172, s23
    v_mov_b32 v173, s23
    v_mov_b32 v174, s23
    v_mov_b32 v175, s23
    v_mov_b32 v176, s23
    v_mov_b32 v177, s23
    v_mov_b32 v178, s23
    v_mov_b32 v179, s23
    v_mov_b32 v180, s23
    v_mov_b32 v181, s23
    v_mov_b32 v182, s23
    v_mov_b32 v183, s23
    v_mov_b32 v184, s23
    v_mov_b32 v185, s23
    v_mov_b32 v186, s23
    v_mov_b32 v187, s23
    v_mov_b32 v188, s23
    v_mov_b32 v189, s23
    v_mov_b32 v190, s23
    v_mov_b32 v191, s23
    v_mov_b32 v192, 0
    v_mov_b32 v193, 0
    v_mov_b32 v194, 0
    v_mov_b32 v195, 0
    v_mov_b32 v196, 0
    v_mov_b32 v197, 0
    v_mov_b32 v198, 0
    v_mov_b32 v199, 0
    v_mov_b32 v200, 0
    v_mov_b32 v201, 0
    v_mov_b32 v202, 0
    v_mov_b32 v203, 0
    v_mov_b32 v204, 0
    v_mov_b32 v205, 0
    v_mov_b32 v206, 0
    v_mov_b32 v207, 0
    v_mov_b32 v208, s23
    v_mov_b32 v209, s23
    v_mov_b32 v210, s23
    v_mov_b32 v211, s23
    v_mov_b32 v212, s23
    v_mov_b32 v213, s23
    v_mov_b32 v214, s23
    v_mov_b32 v215, s23
    v_mov_b32 v216, s23
    v_mov_b32 v217, s23
    v_mov_b32 v218, s23
    v_mov_b32 v219, s23
    v_mov_b32 v220, s23
    v_mov_b32 v221, s23
    v_mov_b32 v222, s23
    v_mov_b32 v223, s23
    v_mov_b32 v224, s23
    v_mov_b32 v225, s23
    v_mov_b32 v226, s23
    v_mov_b32 v227, s23
    v_mov_b32 v228, s23
    v_mov_b32 v229, s23
    v_mov_b32 v230, s23
    v_mov_b32 v231, s23
    v_mov_b32 v232, s23
    v_mov_b32 v233, s23
    v_mov_b32 v234, s23
    v_mov_b32 v235, s23
    v_mov_b32 v236, s23
    v_mov_b32 v237, s23
    v_mov_b32 v238, s23
    v_mov_b32 v239, s23
    v_mov_b32 v240, 0
    v_mov_b32 v241, 0
    v_mov_b32 v242, 0
    v_mov_b32 v243, 0
    v_mov_b32 v244, 0
    v_mov_b32 v245, 0
    v_mov_b32 v246, 0
    v_mov_b32 v247, 0
    v_mov_b32 v248, 0
    v_mov_b32 v249, 0
    v_mov_b32 v250, 0
    v_mov_b32 v251, 0
    v_mov_b32 v252, 0
    v_mov_b32 v253, 0
    v_mov_b32 v254, 0
    v_mov_b32 v255, 0
    s_lshl_b32 s24, s18, 1
    s_add_u32 s24, s24, s22
    s_lshl_b32 s25, s17, 1
    s_add_u32 s25, s25, s21
    s_lshl_b32 s36, s24, 12
    s_lshl_b32 s37, s25, 7
    s_add_u32 s36, s36, s37
    s_add_u32 s36, s36, 13631488
    s_lshl_b32 s37, s24, 3
    v_add_u32 v5, s37, v4
    v_add_u32 v6, 0, v5
    v_mul_u32_u24 v6, 147, v6
    v_lshrrev_b32 v40, 10, v6
    v_add_u32 v7, 0, v1
    v_lshl_add_u32 v22, v40, 17, v7
    v_lshl_add_u32 v26, v40, 18, v7
    v_add_u32 v6, 2, v5
    v_mul_u32_u24 v6, 147, v6
    v_lshrrev_b32 v41, 10, v6
    v_add_u32 v7, 8, v1
    v_lshl_add_u32 v23, v41, 17, v7
    v_lshl_add_u32 v27, v41, 18, v7
    v_add_u32 v6, 4, v5
    v_mul_u32_u24 v6, 147, v6
    v_lshrrev_b32 v42, 10, v6
    v_add_u32 v7, 1024, v1
    v_lshl_add_u32 v24, v42, 17, v7
    v_lshl_add_u32 v28, v42, 18, v7
    v_add_u32 v6, 6, v5
    v_mul_u32_u24 v6, 147, v6
    v_lshrrev_b32 v43, 10, v6
    v_add_u32 v7, 1032, v1
    v_lshl_add_u32 v25, v43, 17, v7
    v_lshl_add_u32 v29, v43, 18, v7
    v_cmp_ne_u32 s[92:93], v40, v41
    v_cmp_ne_u32 s[94:95], v42, v43
    s_lshl_b32 s37, s24, 5
    v_add_u32 v5, s37, v3
    v_mul_u32_u24 v6, 2341, v5
    v_lshrrev_b32 v6, 16, v6
    v_mul_u32_u24 v7, 28, v6
    v_sub_u32 v5, v5, v7
    v_lshl_add_u32 v5, v4, 5, v5
    v_lshlrev_b32 v5, 4, v5
    v_lshl_add_u32 v30, v6, 18, v5
    s_waitcnt lgkmcnt(0)
    s_mov_b32 s52, s50
    s_mov_b32 s53, s51
    s_cmp_eq_u32 s16, 1
    s_cbranch_scc1 L_P1B
    s_cmp_lg_u32 s18, 7
    s_cbranch_scc1 L_P1A
    v_mov_b32 v36, 16843009
    v_and_b32 v37, 31, v2
    v_lshlrev_b32 v37, 2, v37
    s_cmp_lg_u32 s19, 0
    s_cbranch_scc1 L_P1DONE
    s_mov_b32 s62, 0x40000
POLL1:
    buffer_load_dword v36, v37, s[52:55], 0 offen sc1
    s_sub_u32 s62, s62, 1
    s_cbranch_scc1 POLL1_X
    s_waitcnt vmcnt(0)
    v_cmp_eq_u32 vcc, 16843009, v36
    s_nop 0
    s_cmp_eq_u64 vcc, -1
    s_cbranch_scc1 POLL1_X
    s_sleep 16
    s_branch POLL1
POLL1_X:
    s_mul_i32 s28, s38, 28
    s_lshr_b32 s28, s28, 5
    s_lshl_b32 s28, s28, 12
    s_lshl_b32 s29, s39, 8
    s_add_u32 s28, s28, s29
    s_add_u32 s28, s28, 13631488
    v_mov_b32 v8, 0
    s_mov_b32 s62, 0x40000
POLL2:
    buffer_load_dword v9, v8, s[12:15], s28 offen sc1
    s_sub_u32 s62, s62, 1
    s_cbranch_scc1 POLL2_X
    s_waitcnt vmcnt(0)
    v_cmp_eq_u32 vcc, 1, v9
    s_nop 0
    s_cmp_eq_u64 vcc, -1
    s_cbranch_scc1 POLL2_X
    s_sleep 4
    s_branch POLL2
POLL2_X:
    s_branch L_P1DONE
L_P1A:
    s_add_u32 s28, s24, 1
    s_cmp_ge_u32 s24, 7
    s_addc_u32 s28, s28, 0
    s_sub_u32 s29, s28, 1
    s_cmp_eq_u32 s24, 0
    s_cselect_b32 s30, s29, s28
    s_cmp_eq_u32 s24, 7
    s_cselect_b32 s30, s29, s30
    s_sub_u32 s28, s28, s30
    s_lshl_b32 s26, s25, 13
    s_add_u32 s26, s26, 2097152
    s_add_u32 s27, s26, 4096
    s_lshl_b32 s25, s25, 12
    v_mul_u32_u24 v5, s28, v4
    v_add_u32 v5, s30, v5
    v_sub_u32 v6, 7, v5
    v_bfe_u32 v7, v6, 2, 1
    v_lshlrev_b32 v7, 10, v7
    v_and_b32 v8, 1, v6
    v_lshl_add_u32 v7, v8, 9, v7
    v_and_b32 v8, 2, v6
    v_lshl_add_u32 v7, v8, 2, v7
    v_lshl_add_u32 v7, v3, 4, v7
    v_lshl_add_u32 v8, v5, 17, v7
    v_lshl_add_u32 v9, v5, 18, v7
    v_bfe_u32 v6, v2, 4, 1
    v_lshlrev_b32 v6, 12, v6
    v_lshl_add_u32 v6, v5, 18, v6
    v_bfe_u32 v7, v2, 2, 2
    v_lshl_add_u32 v6, v7, 9, v6
    v_and_b32 v7, 3, v2
    v_lshl_add_u32 v6, v7, 4, v6
    v_cmp_eq_u32 vcc, 0, v7
    v_mov_b32 v44, 0x3f803f80
    s_nop 0
    v_cndmask_b32 v44, 0, v44, vcc
    v_mov_b32 v45, v44
    v_mov_b32 v46, v44
    v_mov_b32 v47, v44
    v_mov_b32 v48, 0
    v_mov_b32 v49, 0
    buffer_store_dwordx2 v[48:49], v8, s[12:15], s25 offen sc1
    buffer_store_dwordx2 v[48:49], v8, s[12:15], s25 offen offset:2048 sc1
    buffer_store_dwordx2 v[48:49], v9, s[12:15], s26 offen sc1
    buffer_store_dwordx2 v[48:49], v9, s[12:15], s27 offen sc1
    buffer_store_dwordx4 v[44:47], v6, s[12:15], s26 offen offset:2496 sc1
    s_barrier
    ds_read_b128 v[64:67], v10 offset:40960
    ds_read_b128 v[68:71], v10 offset:45056
    ds_read_b64_tr_b16 v[72:73], v14 offset:40960
    ds_read_b64_tr_b16 v[74:75], v14 offset:41472
    ds_read_b64_tr_b16 v[76:77], v14 offset:49152
    ds_read_b64_tr_b16 v[78:79], v14 offset:49664
    ds_read_b64_tr_b16 v[80:81], v14 offset:57344
    ds_read_b64_tr_b16 v[82:83], v14 offset:57856
    s_waitcnt lgkmcnt(0)
    v_mfma_f32_32x32x16_bf16 v[192:207], v[64:67], v[80:83], v[192:207]
    ds_read_b128 v[84:87], v11 offset:40960
    ds_read_b128 v[88:91], v11 offset:45056
    v_mfma_f32_32x32x16_bf16 v[240:255], v[68:71], v[80:83], v[240:255]
    ds_read_b64_tr_b16 v[92:93], v14 offset:43008
    ds_read_b64_tr_b16 v[94:95], v14 offset:43520
    v_mfma_f32_32x32x16_bf16 v[176:191], v[76:79], v[64:67], v[176:191]
    ds_read_b64_tr_b16 v[96:97], v14 offset:51200
    ds_read_b64_tr_b16 v[98:99], v14 offset:51712
    v_mfma_f32_32x32x16_bf16 v[224:239], v[76:79], v[68:71], v[224:239]
    ds_read_b64_tr_b16 v[100:101], v14 offset:59392
    ds_read_b64_tr_b16 v[102:103], v14 offset:59904
    v_mfma_f32_32x32x16_bf16 v[160:175], v[72:75], v[64:67], v[160:175]
    v_mfma_f32_32x32x16_bf16 v[208:223], v[72:75], v[68:71], v[208:223]
    s_waitcnt lgkmcnt(0)
    v_mfma_f32_32x32x16_bf16 v[192:207], v[84:87], v[100:103], v[192:207]
    ds_read_b128 v[64:67], v12 offset:40960
    ds_read_b128 v[68:71], v12 offset:45056
    v_mfma_f32_32x32x16_bf16 v[240:255], v[88:91], v[100:103], v[240:255]
    ds_read_b64_tr_b16 v[72:73], v14 offset:45056
    ds_read_b64_tr_b16 v[74:75], v14 offset:45568
    v_mfma_f32_32x32x16_bf16 v[176:191], v[96:99], v[84:87], v[176:191]
    ds_read_b64_tr_b16 v[76:77], v14 offset:53248
    ds_read_b64_tr_b16 v[78:79], v14 offset:53760
    v_mfma_f32_32x32x16_bf16 v[224:239], v[96:99], v[88:91], v[224:239]
    ds_read_b64_tr_b16 v[80:81], v14 offset:61440
    ds_read_b64_tr_b16 v[82:83], v14 offset:61952
    v_mfma_f32_32x32x16_bf16 v[160:175], v[92:95], v[84:87], v[160:175]
    v_mfma_f32_32x32x16_bf16 v[208:223], v[92:95], v[88:91], v[208:223]
    s_waitcnt lgkmcnt(0)
    v_mfma_f32_32x32x16_bf16 v[192:207], v[64:67], v[80:83], v[192:207]
    ds_read_b128 v[84:87], v13 offset:40960
    ds_read_b128 v[88:91], v13 offset:45056
    v_mfma_f32_32x32x16_bf16 v[240:255], v[68:71], v[80:83], v[240:255]
    ds_read_b64_tr_b16 v[92:93], v14 offset:47104
    ds_read_b64_tr_b16 v[94:95], v14 offset:47616
    v_mfma_f32_32x32x16_bf16 v[176:191], v[76:79], v[64:67], v[176:191]
    ds_read_b64_tr_b16 v[96:97], v14 offset:55296
    ds_read_b64_tr_b16 v[98:99], v14 offset:55808
    v_mfma_f32_32x32x16_bf16 v[224:239], v[76:79], v[68:71], v[224:239]
    ds_read_b64_tr_b16 v[100:101], v14 offset:63488
    ds_read_b64_tr_b16 v[102:103], v14 offset:64000
    v_mfma_f32_32x32x16_bf16 v[160:175], v[72:75], v[64:67], v[160:175]
    v_mfma_f32_32x32x16_bf16 v[208:223], v[72:75], v[68:71], v[208:223]
    s_waitcnt lgkmcnt(0)
    s_barrier
    v_mfma_f32_32x32x16_bf16 v[192:207], v[84:87], v[100:103], v[192:207]
    ds_read_b128 v[64:67], v16 offset:0
    ds_read_b128 v[68:71], v16 offset:4096
    v_mfma_f32_32x32x16_bf16 v[240:255], v[88:91], v[100:103], v[240:255]
    ds_read_b64_tr_b16 v[72:73], v15 offset:0
    ds_read_b64_tr_b16 v[74:75], v15 offset:512
    v_mfma_f32_32x32x16_bf16 v[176:191], v[96:99], v[84:87], v[176:191]
    ds_read_b64_tr_b16 v[76:77], v15 offset:8192
    ds_read_b64_tr_b16 v[78:79], v15 offset:8704
    v_mfma_f32_32x32x16_bf16 v[224:239], v[96:99], v[88:91], v[224:239]
    ds_read_b64_tr_b16 v[80:81], v15 offset:16384
    ds_read_b64_tr_b16 v[82:83], v15 offset:16896
    v_mfma_f32_32x32x16_bf16 v[160:175], v[92:95], v[84:87], v[160:175]
    v_mfma_f32_32x32x16_bf16 v[208:223], v[92:95], v[88:91], v[208:223]
    s_waitcnt lgkmcnt(0)
    v_mfma_f32_32x32x16_bf16 v[192:207], v[64:67], v[80:83], v[192:207]
    ds_read_b128 v[84:87], v17 offset:0
    ds_read_b128 v[88:91], v17 offset:4096
    v_mfma_f32_32x32x16_bf16 v[240:255], v[68:71], v[80:83], v[240:255]
    ds_read_b64_tr_b16 v[92:93], v15 offset:2048
    ds_read_b64_tr_b16 v[94:95], v15 offset:2560
    v_mfma_f32_32x32x16_bf16 v[176:191], v[76:79], v[64:67], v[176:191]
    ds_read_b64_tr_b16 v[96:97], v15 offset:10240
    ds_read_b64_tr_b16 v[98:99], v15 offset:10752
    v_mfma_f32_32x32x16_bf16 v[224:239], v[76:79], v[68:71], v[224:239]
    ds_read_b64_tr_b16 v[100:101], v15 offset:18432
    ds_read_b64_tr_b16 v[102:103], v15 offset:18944
    v_mfma_f32_32x32x16_bf16 v[160:175], v[72:75], v[64:67], v[160:175]
    v_mfma_f32_32x32x16_bf16 v[208:223], v[72:75], v[68:71], v[208:223]
    s_waitcnt lgkmcnt(0)
    v_mfma_f32_32x32x16_bf16 v[192:207], v[84:87], v[100:103], v[192:207]
    ds_read_b128 v[64:67], v18 offset:0
    ds_read_b128 v[68:71], v18 offset:4096
    v_mfma_f32_32x32x16_bf16 v[240:255], v[88:91], v[100:103], v[240:255]
    ds_read_b64_tr_b16 v[72:73], v15 offset:4096
    ds_read_b64_tr_b16 v[74:75], v15 offset:4608
    v_mfma_f32_32x32x16_bf16 v[176:191], v[96:99], v[84:87], v[176:191]
    ds_read_b64_tr_b16 v[76:77], v15 offset:12288
    ds_read_b64_tr_b16 v[78:79], v15 offset:12800
    v_mfma_f32_32x32x16_bf16 v[224:239], v[96:99], v[88:91], v[224:239]
    ds_read_b64_tr_b16 v[80:81], v15 offset:20480
    ds_read_b64_tr_b16 v[82:83], v15 offset:20992
    v_mfma_f32_32x32x16_bf16 v[160:175], v[92:95], v[84:87], v[160:175]
    v_mfma_f32_32x32x16_bf16 v[208:223], v[92:95], v[88:91], v[208:223]
    s_waitcnt lgkmcnt(0)
    v_mfma_f32_32x32x16_bf16 v[192:207], v[64:67], v[80:83], v[192:207]
    ds_read_b128 v[84:87], v19 offset:0
    ds_read_b128 v[88:91], v19 offset:4096
    v_mfma_f32_32x32x16_bf16 v[240:255], v[68:71], v[80:83], v[240:255]
    ds_read_b64_tr_b16 v[92:93], v15 offset:6144
    ds_read_b64_tr_b16 v[94:95], v15 offset:6656
    v_mfma_f32_32x32x16_bf16 v[176:191], v[76:79], v[64:67], v[176:191]
    ds_read_b64_tr_b16 v[96:97], v15 offset:14336
    ds_read_b64_tr_b16 v[98:99], v15 offset:14848
    v_mfma_f32_32x32x16_bf16 v[224:239], v[76:79], v[68:71], v[224:239]
    ds_read_b64_tr_b16 v[100:101], v15 offset:22528
    ds_read_b64_tr_b16 v[102:103], v15 offset:23040
    v_mfma_f32_32x32x16_bf16 v[160:175], v[72:75], v[64:67], v[160:175]
    v_mfma_f32_32x32x16_bf16 v[208:223], v[72:75], v[68:71], v[208:223]
    s_waitcnt lgkmcnt(0)
    s_barrier
    v_mfma_f32_32x32x16_bf16 v[192:207], v[84:87], v[100:103], v[192:207]
    ds_read_b128 v[64:67], v16 offset:40960
    ds_read_b128 v[68:71], v16 offset:45056
    v_mfma_f32_32x32x16_bf16 v[240:255], v[88:91], v[100:103], v[240:255]
    ds_read_b64_tr_b16 v[72:73], v15 offset:40960
    ds_read_b64_tr_b16 v[74:75], v15 offset:41472
    v_mfma_f32_32x32x16_bf16 v[176:191], v[96:99], v[84:87], v[176:191]
    ds_read_b64_tr_b16 v[76:77], v15 offset:49152
    ds_read_b64_tr_b16 v[78:79], v15 offset:49664
    v_mfma_f32_32x32x16_bf16 v[224:239], v[96:99], v[88:91], v[224:239]
    ds_read_b64_tr_b16 v[80:81], v15 offset:57344
    ds_read_b64_tr_b16 v[82:83], v15 offset:57856
    v_mfma_f32_32x32x16_bf16 v[160:175], v[92:95], v[84:87], v[160:175]
    v_mfma_f32_32x32x16_bf16 v[208:223], v[92:95], v[88:91], v[208:223]
    s_waitcnt lgkmcnt(0)
    v_mfma_f32_32x32x16_bf16 v[192:207], v[64:67], v[80:83], v[192:207]
    ds_read_b128 v[84:87], v17 offset:40960
    ds_read_b128 v[88:91], v17 offset:45056
    v_mfma_f32_32x32x16_bf16 v[240:255], v[68:71], v[80:83], v[240:255]
    ds_read_b64_tr_b16 v[92:93], v15 offset:43008
    ds_read_b64_tr_b16 v[94:95], v15 offset:43520
    v_mfma_f32_32x32x16_bf16 v[176:191], v[76:79], v[64:67], v[176:191]
    ds_read_b64_tr_b16 v[96:97], v15 offset:51200
    ds_read_b64_tr_b16 v[98:99], v15 offset:51712
    v_mfma_f32_32x32x16_bf16 v[224:239], v[76:79], v[68:71], v[224:239]
    ds_read_b64_tr_b16 v[100:101], v15 offset:59392
    ds_read_b64_tr_b16 v[102:103], v15 offset:59904
    v_mfma_f32_32x32x16_bf16 v[160:175], v[72:75], v[64:67], v[160:175]
    v_mfma_f32_32x32x16_bf16 v[208:223], v[72:75], v[68:71], v[208:223]
    s_waitcnt lgkmcnt(0)
    v_mfma_f32_32x32x16_bf16 v[192:207], v[84:87], v[100:103], v[192:207]
    ds_read_b128 v[64:67], v18 offset:40960
    ds_read_b128 v[68:71], v18 offset:45056
    v_mfma_f32_32x32x16_bf16 v[240:255], v[88:91], v[100:103], v[240:255]
    ds_read_b64_tr_b16 v[72:73], v15 offset:45056
    ds_read_b64_tr_b16 v[74:75], v15 offset:45568
    v_mfma_f32_32x32x16_bf16 v[176:191], v[96:99], v[84:87], v[176:191]
    ds_read_b64_tr_b16 v[76:77], v15 offset:53248
    ds_read_b64_tr_b16 v[78:79], v15 offset:53760
    v_mfma_f32_32x32x16_bf16 v[224:239], v[96:99], v[88:91], v[224:239]
    ds_read_b64_tr_b16 v[80:81], v15 offset:61440
    ds_read_b64_tr_b16 v[82:83], v15 offset:61952
    v_mfma_f32_32x32x16_bf16 v[160:175], v[92:95], v[84:87], v[160:175]
    v_mfma_f32_32x32x16_bf16 v[208:223], v[92:95], v[88:91], v[208:223]
    s_waitcnt lgkmcnt(0)
    v_mfma_f32_32x32x16_bf16 v[192:207], v[64:67], v[80:83], v[192:207]
    ds_read_b128 v[84:87], v19 offset:40960
    ds_read_b128 v[88:91], v19 offset:45056
    v_mfma_f32_32x32x16_bf16 v[240:255], v[68:71], v[80:83], v[240:255]
    ds_read_b64_tr_b16 v[92:93], v15 offset:47104
    ds_read_b64_tr_b16 v[94:95], v15 offset:47616
    v_mfma_f32_32x32x16_bf16 v[176:191], v[76:79], v[64:67], v[176:191]
    ds_read_b64_tr_b16 v[96:97], v15 offset:55296
    ds_read_b64_tr_b16 v[98:99], v15 offset:55808
    v_mfma_f32_32x32x16_bf16 v[224:239], v[76:79], v[68:71], v[224:239]
    ds_read_b64_tr_b16 v[100:101], v15 offset:63488
    ds_read_b64_tr_b16 v[102:103], v15 offset:64000
    v_mfma_f32_32x32x16_bf16 v[160:175], v[72:75], v[64:67], v[160:175]
    v_mfma_f32_32x32x16_bf16 v[208:223], v[72:75], v[68:71], v[208:223]
    s_waitcnt lgkmcnt(0)
    s_barrier
    v_mfma_f32_32x32x16_bf16 v[192:207], v[84:87], v[100:103], v[192:207]
    ds_read_b128 v[64:67], v10 offset:0
    ds_read_b128 v[68:71], v10 offset:4096
    v_mfma_f32_32x32x16_bf16 v[240:255], v[88:91], v[100:103], v[240:255]
    ds_read_b64_tr_b16 v[72:73], v14 offset:0
    ds_read_b64_tr_b16 v[74:75], v14 offset:512
    v_mfma_f32_32x32x16_bf16 v[176:191], v[96:99], v[84:87], v[176:191]
    ds_read_b64_tr_b16 v[76:77], v14 offset:8192
    ds_read_b64_tr_b16 v[78:79], v14 offset:8704
    v_mfma_f32_32x32x16_bf16 v[224:239], v[96:99], v[88:91], v[224:239]
    ds_read_b64_tr_b16 v[80:81], v14 offset:16384
    ds_read_b64_tr_b16 v[82:83], v14 offset:16896
    v_mfma_f32_32x32x16_bf16 v[160:175], v[92:95], v[84:87], v[160:175]
    v_mfma_f32_32x32x16_bf16 v[208:223], v[92:95], v[88:91], v[208:223]
    s_waitcnt lgkmcnt(0)
    v_mfma_f32_32x32x16_bf16 v[192:207], v[64:67], v[80:83], v[192:207]
    ds_read_b128 v[84:87], v11 offset:0
    ds_read_b128 v[88:91], v11 offset:4096
    v_mfma_f32_32x32x16_bf16 v[240:255], v[68:71], v[80:83], v[240:255]
    ds_read_b64_tr_b16 v[92:93], v14 offset:2048
    ds_read_b64_tr_b16 v[94:95], v14 offset:2560
    v_mfma_f32_32x32x16_bf16 v[176:191], v[76:79], v[64:67], v[176:191]
    ds_read_b64_tr_b16 v[96:97], v14 offset:10240
    ds_read_b64_tr_b16 v[98:99], v14 offset:10752
    v_mfma_f32_32x32x16_bf16 v[224:239], v[76:79], v[68:71], v[224:239]
    ds_read_b64_tr_b16 v[100:101], v14 offset:18432
    ds_read_b64_tr_b16 v[102:103], v14 offset:18944
    v_mfma_f32_32x32x16_bf16 v[160:175], v[72:75], v[64:67], v[160:175]
    v_mfma_f32_32x32x16_bf16 v[208:223], v[72:75], v[68:71], v[208:223]
    s_waitcnt lgkmcnt(0)
    v_mfma_f32_32x32x16_bf16 v[192:207], v[84:87], v[100:103], v[192:207]
    ds_read_b128 v[64:67], v12 offset:0
    ds_read_b128 v[68:71], v12 offset:4096
    v_mfma_f32_32x32x16_bf16 v[240:255], v[88:91], v[100:103], v[240:255]
    ds_read_b64_tr_b16 v[72:73], v14 offset:4096
    ds_read_b64_tr_b16 v[74:75], v14 offset:4608
    v_mfma_f32_32x32x16_bf16 v[176:191], v[96:99], v[84:87], v[176:191]
    ds_read_b64_tr_b16 v[76:77], v14 offset:12288
    ds_read_b64_tr_b16 v[78:79], v14 offset:12800
    v_mfma_f32_32x32x16_bf16 v[224:239], v[96:99], v[88:91], v[224:239]
    ds_read_b64_tr_b16 v[80:81], v14 offset:20480
    ds_read_b64_tr_b16 v[82:83], v14 offset:20992
    v_mfma_f32_32x32x16_bf16 v[160:175], v[92:95], v[84:87], v[160:175]
    v_mfma_f32_32x32x16_bf16 v[208:223], v[92:95], v[88:91], v[208:223]
    s_waitcnt lgkmcnt(0)
    v_mfma_f32_32x32x16_bf16 v[192:207], v[64:67], v[80:83], v[192:207]
    ds_read_b128 v[84:87], v13 offset:0
    ds_read_b128 v[88:91], v13 offset:4096
    v_mfma_f32_32x32x16_bf16 v[240:255], v[68:71], v[80:83], v[240:255]
    ds_read_b64_tr_b16 v[92:93], v14 offset:6144
    ds_read_b64_tr_b16 v[94:95], v14 offset:6656
    v_mfma_f32_32x32x16_bf16 v[176:191], v[76:79], v[64:67], v[176:191]
    ds_read_b64_tr_b16 v[96:97], v14 offset:14336
    ds_read_b64_tr_b16 v[98:99], v14 offset:14848
    v_mfma_f32_32x32x16_bf16 v[224:239], v[76:79], v[68:71], v[224:239]
    ds_read_b64_tr_b16 v[100:101], v14 offset:22528
    ds_read_b64_tr_b16 v[102:103], v14 offset:23040
    v_mfma_f32_32x32x16_bf16 v[160:175], v[72:75], v[64:67], v[160:175]
    v_mfma_f32_32x32x16_bf16 v[208:223], v[72:75], v[68:71], v[208:223]
    s_waitcnt lgkmcnt(0)
    s_barrier
    v_mfma_f32_32x32x16_bf16 v[192:207], v[84:87], v[100:103], v[192:207]
    ds_read_b128 v[64:67], v10 offset:40960
    ds_read_b128 v[68:71], v10 offset:45056
    v_mfma_f32_32x32x16_bf16 v[240:255], v[88:91], v[100:103], v[240:255]
    ds_read_b64_tr_b16 v[72:73], v14 offset:40960
    ds_read_b64_tr_b16 v[74:75], v14 offset:41472
    v_mfma_f32_32x32x16_bf16 v[176:191], v[96:99], v[84:87], v[176:191]
    ds_read_b64_tr_b16 v[76:77], v14 offset:49152
    ds_read_b64_tr_b16 v[78:79], v14 offset:49664
    v_mfma_f32_32x32x16_bf16 v[224:239], v[96:99], v[88:91], v[224:239]
    ds_read_b64_tr_b16 v[80:81], v14 offset:57344
    ds_read_b64_tr_b16 v[82:83], v14 offset:57856
    v_mfma_f32_32x32x16_bf16 v[160:175], v[92:95], v[84:87], v[160:175]
    v_mfma_f32_32x32x16_bf16 v[208:223], v[92:95], v[88:91], v[208:223]
    s_waitcnt lgkmcnt(0)
    v_mfma_f32_32x32x16_bf16 v[192:207], v[64:67], v[80:83], v[192:207]
    ds_read_b128 v[84:87], v11 offset:40960
    ds_read_b128 v[88:91], v11 offset:45056
    v_mfma_f32_32x32x16_bf16 v[240:255], v[68:71], v[80:83], v[240:255]
    ds_read_b64_tr_b16 v[92:93], v14 offset:43008
    ds_read_b64_tr_b16 v[94:95], v14 offset:43520
    v_mfma_f32_32x32x16_bf16 v[176:191], v[76:79], v[64:67], v[176:191]
    ds_read_b64_tr_b16 v[96:97], v14 offset:51200
    ds_read_b64_tr_b16 v[98:99], v14 offset:51712
    v_mfma_f32_32x32x16_bf16 v[224:239], v[76:79], v[68:71], v[224:239]
    ds_read_b64_tr_b16 v[100:101], v14 offset:59392
    ds_read_b64_tr_b16 v[102:103], v14 offset:59904
    v_mfma_f32_32x32x16_bf16 v[160:175], v[72:75], v[64:67], v[160:175]
    v_mfma_f32_32x32x16_bf16 v[208:223], v[72:75], v[68:71], v[208:223]
    s_waitcnt lgkmcnt(0)
    v_mfma_f32_32x32x16_bf16 v[192:207], v[84:87], v[100:103], v[192:207]
    ds_read_b128 v[64:67], v12 offset:40960
    ds_read_b128 v[68:71], v12 offset:45056
    v_mfma_f32_32x32x16_bf16 v[240:255], v[88:91], v[100:103], v[240:255]
    ds_read_b64_tr_b16 v[72:73], v14 offset:45056
    ds_read_b64_tr_b16 v[74:75], v14 offset:45568
    v_mfma_f32_32x32x16_bf16 v[176:191], v[96:99], v[84:87], v[176:191]
    ds_read_b64_tr_b16 v[76:77], v14 offset:53248
    ds_read_b64_tr_b16 v[78:79], v14 offset:53760
    v_mfma_f32_32x32x16_bf16 v[224:239], v[96:99], v[88:91], v[224:239]
    ds_read_b64_tr_b16 v[80:81], v14 offset:61440
    ds_read_b64_tr_b16 v[82:83], v14 offset:61952
    v_mfma_f32_32x32x16_bf16 v[160:175], v[92:95], v[84:87], v[160:175]
    v_mfma_f32_32x32x16_bf16 v[208:223], v[92:95], v[88:91], v[208:223]
    s_waitcnt lgkmcnt(0)
    v_mfma_f32_32x32x16_bf16 v[192:207], v[64:67], v[80:83], v[192:207]
    ds_read_b128 v[84:87], v13 offset:40960
    ds_read_b128 v[88:91], v13 offset:45056
    v_mfma_f32_32x32x16_bf16 v[240:255], v[68:71], v[80:83], v[240:255]
    ds_read_b64_tr_b16 v[92:93], v14 offset:47104
    ds_read_b64_tr_b16 v[94:95], v14 offset:47616
    v_mfma_f32_32x32x16_bf16 v[176:191], v[76:79], v[64:67], v[176:191]
    ds_read_b64_tr_b16 v[96:97], v14 offset:55296
    ds_read_b64_tr_b16 v[98:99], v14 offset:55808
    v_mfma_f32_32x32x16_bf16 v[224:239], v[76:79], v[68:71], v[224:239]
    ds_read_b64_tr_b16 v[100:101], v14 offset:63488
    ds_read_b64_tr_b16 v[102:103], v14 offset:64000
    v_mfma_f32_32x32x16_bf16 v[160:175], v[72:75], v[64:67], v[160:175]
    v_mfma_f32_32x32x16_bf16 v[208:223], v[72:75], v[68:71], v[208:223]
    s_waitcnt lgkmcnt(0)
    s_barrier
    v_mfma_f32_32x32x16_bf16 v[192:207], v[84:87], v[100:103], v[192:207]
    ds_read_b128 v[64:67], v16 offset:0
    ds_read_b128 v[68:71], v16 offset:4096
    v_mfma_f32_32x32x16_bf16 v[240:255], v[88:91], v[100:103], v[240:255]
    ds_read_b64_tr_b16 v[72:73], v15 offset:0
    ds_read_b64_tr_b16 v[74:75], v15 offset:512
    v_mfma_f32_32x32x16_bf16 v[176:191], v[96:99], v[84:87], v[176:191]
    ds_read_b64_tr_b16 v[76:77], v15 offset:8192
    ds_read_b64_tr_b16 v[78:79], v15 offset:8704
    v_mfma_f32_32x32x16_bf16 v[224:239], v[96:99], v[88:91], v[224:239]
    ds_read_b64_tr_b16 v[80:81], v15 offset:16384
    ds_read_b64_tr_b16 v[82:83], v15 offset:16896
    v_mfma_f32_32x32x16_bf16 v[160:175], v[92:95], v[84:87], v[160:175]
    v_mfma_f32_32x32x16_bf16 v[208:223], v[92:95], v[88:91], v[208:223]
    s_waitcnt lgkmcnt(0)
    v_mfma_f32_32x32x16_bf16 v[192:207], v[64:67], v[80:83], v[192:207]
    ds_read_b128 v[84:87], v17 offset:0
    ds_read_b128 v[88:91], v17 offset:4096
    v_mfma_f32_32x32x16_bf16 v[240:255], v[68:71], v[80:83], v[240:255]
    ds_read_b64_tr_b16 v[92:93], v15 offset:2048
    ds_read_b64_tr_b16 v[94:95], v15 offset:2560
    v_mfma_f32_32x32x16_bf16 v[176:191], v[76:79], v[64:67], v[176:191]
    ds_read_b64_tr_b16 v[96:97], v15 offset:10240
    ds_read_b64_tr_b16 v[98:99], v15 offset:10752
    v_mfma_f32_32x32x16_bf16 v[224:239], v[76:79], v[68:71], v[224:239]
    ds_read_b64_tr_b16 v[100:101], v15 offset:18432
    ds_read_b64_tr_b16 v[102:103], v15 offset:18944
    v_mfma_f32_32x32x16_bf16 v[160:175], v[72:75], v[64:67], v[160:175]
    v_mfma_f32_32x32x16_bf16 v[208:223], v[72:75], v[68:71], v[208:223]
    s_waitcnt lgkmcnt(0)
    v_mfma_f32_32x32x16_bf16 v[192:207], v[84:87], v[100:103], v[192:207]
    ds_read_b128 v[64:67], v18 offset:0
    ds_read_b128 v[68:71], v18 offset:4096
    v_mfma_f32_32x32x16_bf16 v[240:255], v[88:91], v[100:103], v[240:255]
    ds_read_b64_tr_b16 v[72:73], v15 offset:4096
    ds_read_b64_tr_b16 v[74:75], v15 offset:4608
    v_mfma_f32_32x32x16_bf16 v[176:191], v[96:99], v[84:87], v[176:191]
    ds_read_b64_tr_b16 v[76:77], v15 offset:12288
    ds_read_b64_tr_b16 v[78:79], v15 offset:12800
    v_mfma_f32_32x32x16_bf16 v[224:239], v[96:99], v[88:91], v[224:239]
    ds_read_b64_tr_b16 v[80:81], v15 offset:20480
    ds_read_b64_tr_b16 v[82:83], v15 offset:20992
    v_mfma_f32_32x32x16_bf16 v[160:175], v[92:95], v[84:87], v[160:175]
    v_mfma_f32_32x32x16_bf16 v[208:223], v[92:95], v[88:91], v[208:223]
    s_waitcnt lgkmcnt(0)
    v_mfma_f32_32x32x16_bf16 v[192:207], v[64:67], v[80:83], v[192:207]
    ds_read_b128 v[84:87], v19 offset:0
    ds_read_b128 v[88:91], v19 offset:4096
    v_mfma_f32_32x32x16_bf16 v[240:255], v[68:71], v[80:83], v[240:255]
    ds_read_b64_tr_b16 v[92:93], v15 offset:6144
    ds_read_b64_tr_b16 v[94:95], v15 offset:6656
    v_mfma_f32_32x32x16_bf16 v[176:191], v[76:79], v[64:67], v[176:191]
    ds_read_b64_tr_b16 v[96:97], v15 offset:14336
    ds_read_b64_tr_b16 v[98:99], v15 offset:14848
    v_mfma_f32_32x32x16_bf16 v[224:239], v[76:79], v[68:71], v[224:239]
    ds_read_b64_tr_b16 v[100:101], v15 offset:22528
    ds_read_b64_tr_b16 v[102:103], v15 offset:23040
    v_mfma_f32_32x32x16_bf16 v[160:175], v[72:75], v[64:67], v[160:175]
    v_mfma_f32_32x32x16_bf16 v[208:223], v[72:75], v[68:71], v[208:223]
    s_waitcnt lgkmcnt(0)
    s_barrier
    v_mfma_f32_32x32x16_bf16 v[192:207], v[84:87], v[100:103], v[192:207]
    ds_read_b128 v[64:67], v16 offset:40960
    ds_read_b128 v[68:71], v16 offset:45056
    v_mfma_f32_32x32x16_bf16 v[240:255], v[88:91], v[100:103], v[240:255]
    ds_read_b64_tr_b16 v[72:73], v15 offset:40960
    ds_read_b64_tr_b16 v[74:75], v15 offset:41472
    v_mfma_f32_32x32x16_bf16 v[176:191], v[96:99], v[84:87], v[176:191]
    ds_read_b64_tr_b16 v[76:77], v15 offset:49152
    ds_read_b64_tr_b16 v[78:79], v15 offset:49664
    v_mfma_f32_32x32x16_bf16 v[224:239], v[96:99], v[88:91], v[224:239]
    ds_read_b64_tr_b16 v[80:81], v15 offset:57344
    ds_read_b64_tr_b16 v[82:83], v15 offset:57856
    v_mfma_f32_32x32x16_bf16 v[160:175], v[92:95], v[84:87], v[160:175]
    v_mfma_f32_32x32x16_bf16 v[208:223], v[92:95], v[88:91], v[208:223]
    s_waitcnt lgkmcnt(0)
    v_mfma_f32_32x32x16_bf16 v[192:207], v[64:67], v[80:83], v[192:207]
    ds_read_b128 v[84:87], v17 offset:40960
    ds_read_b128 v[88:91], v17 offset:45056
    v_mfma_f32_32x32x16_bf16 v[240:255], v[68:71], v[80:83], v[240:255]
    ds_read_b64_tr_b16 v[92:93], v15 offset:43008
    ds_read_b64_tr_b16 v[94:95], v15 offset:43520
    v_mfma_f32_32x32x16_bf16 v[176:191], v[76:79], v[64:67], v[176:191]
    ds_read_b64_tr_b16 v[96:97], v15 offset:51200
    ds_read_b64_tr_b16 v[98:99], v15 offset:51712
    v_mfma_f32_32x32x16_bf16 v[224:239], v[76:79], v[68:71], v[224:239]
    ds_read_b64_tr_b16 v[100:101], v15 offset:59392
    ds_read_b64_tr_b16 v[102:103], v15 offset:59904
    v_mfma_f32_32x32x16_bf16 v[160:175], v[72:75], v[64:67], v[160:175]
    v_mfma_f32_32x32x16_bf16 v[208:223], v[72:75], v[68:71], v[208:223]
    s_waitcnt lgkmcnt(0)
    v_mfma_f32_32x32x16_bf16 v[192:207], v[84:87], v[100:103], v[192:207]
    ds_read_b128 v[64:67], v18 offset:40960
    ds_read_b128 v[68:71], v18 offset:45056
    v_mfma_f32_32x32x16_bf16 v[240:255], v[88:91], v[100:103], v[240:255]
    ds_read_b64_tr_b16 v[72:73], v15 offset:45056
    ds_read_b64_tr_b16 v[74:75], v15 offset:45568
    v_mfma_f32_32x32x16_bf16 v[176:191], v[96:99], v[84:87], v[176:191]
    ds_read_b64_tr_b16 v[76:77], v15 offset:53248
    ds_read_b64_tr_b16 v[78:79], v15 offset:53760
    v_mfma_f32_32x32x16_bf16 v[224:239], v[96:99], v[88:91], v[224:239]
    ds_read_b64_tr_b16 v[80:81], v15 offset:61440
    ds_read_b64_tr_b16 v[82:83], v15 offset:61952
    v_mfma_f32_32x32x16_bf16 v[160:175], v[92:95], v[84:87], v[160:175]
    v_mfma_f32_32x32x16_bf16 v[208:223], v[92:95], v[88:91], v[208:223]
    s_waitcnt lgkmcnt(0)
    v_mfma_f32_32x32x16_bf16 v[192:207], v[64:67], v[80:83], v[192:207]
    ds_read_b128 v[84:87], v19 offset:40960
    ds_read_b128 v[88:91], v19 offset:45056
    v_mfma_f32_32x32x16_bf16 v[240:255], v[68:71], v[80:83], v[240:255]
    ds_read_b64_tr_b16 v[92:93], v15 offset:47104
    ds_read_b64_tr_b16 v[94:95], v15 offset:47616
    v_mfma_f32_32x32x16_bf16 v[176:191], v[76:79], v[64:67], v[176:191]
    ds_read_b64_tr_b16 v[96:97], v15 offset:55296
    ds_read_b64_tr_b16 v[98:99], v15 offset:55808
    v_mfma_f32_32x32x16_bf16 v[224:239], v[76:79], v[68:71], v[224:239]
    ds_read_b64_tr_b16 v[100:101], v15 offset:63488
    ds_read_b64_tr_b16 v[102:103], v15 offset:64000
    v_mfma_f32_32x32x16_bf16 v[160:175], v[72:75], v[64:67], v[160:175]
    v_mfma_f32_32x32x16_bf16 v[208:223], v[72:75], v[68:71], v[208:223]
    s_waitcnt lgkmcnt(0)
    s_barrier
    v_mfma_f32_32x32x16_bf16 v[192:207], v[84:87], v[100:103], v[192:207]
    v_mfma_f32_32x32x16_bf16 v[240:255], v[88:91], v[100:103], v[240:255]
    v_mfma_f32_32x32x16_bf16 v[176:191], v[96:99], v[84:87], v[176:191]
    v_mfma_f32_32x32x16_bf16 v[224:239], v[96:99], v[88:91], v[224:239]
    v_mfma_f32_32x32x16_bf16 v[160:175], v[92:95], v[84:87], v[160:175]
    v_mfma_f32_32x32x16_bf16 v[208:223], v[92:95], v[88:91], v[208:223]
    v_and_b32 v37, 31, v2
    v_lshlrev_b32 v37, 2, v37
    buffer_load_dword v36, v37, s[52:55], 0 offen sc1
    s_mov_b32 s30, 1049335798
    s_mov_b32 s31, 1049335798
    s_nop 1
    v_cvt_pk_bf16_f32 v64, v192, v193
    v_cvt_pk_bf16_f32 v65, v194, v195
    v_cvt_pk_bf16_f32 v66, v196, v197
    v_cvt_pk_bf16_f32 v67, v198, v199
    v_cvt_pk_bf16_f32 v68, v200, v201
    v_cvt_pk_bf16_f32 v69, v202, v203
    v_cvt_pk_bf16_f32 v70, v204, v205
    v_cvt_pk_bf16_f32 v71, v206, v207
    buffer_store_dwordx4 v[64:67], v30, s[12:15], s26 offen offset:2048 sc1
    buffer_store_dwordx4 v[68:71], v30, s[12:15], s26 offen offset:3072 sc1
    v_cvt_pk_bf16_f32 v72, v240, v241
    v_cvt_pk_bf16_f32 v73, v242, v243
    v_cvt_pk_bf16_f32 v74, v244, v245
    v_cvt_pk_bf16_f32 v75, v246, v247
    v_cvt_pk_bf16_f32 v76, v248, v249
    v_cvt_pk_bf16_f32 v77, v250, v251
    v_cvt_pk_bf16_f32 v78, v252, v253
    v_cvt_pk_bf16_f32 v79, v254, v255
    buffer_store_dwordx4 v[72:75], v30, s[12:15], s27 offen offset:2048 sc1
    buffer_store_dwordx4 v[76:79], v30, s[12:15], s27 offen offset:3072 sc1
    v_cvt_pk_bf16_f32 v80, v176, v177
    v_cvt_pk_bf16_f32 v81, v178, v179
    v_cvt_pk_bf16_f32 v82, v180, v181
    v_cvt_pk_bf16_f32 v83, v182, v183
    v_cvt_pk_bf16_f32 v84, v184, v185
    v_cvt_pk_bf16_f32 v85, v186, v187
    v_cvt_pk_bf16_f32 v86, v188, v189
    v_cvt_pk_bf16_f32 v87, v190, v191
    s_not_b64 exec, s[92:93]
    buffer_store_dwordx4 v[80:83], v26, s[12:15], s26 offen offset:0 sc1
    s_mov_b64 exec, s[92:93]
    s_cbranch_execz PC3
    buffer_store_dwordx2 v[80:81], v26, s[12:15], s26 offen offset:0 sc1
    buffer_store_dwordx2 v[82:83], v27, s[12:15], s26 offen offset:0 sc1
PC3:
    s_not_b64 exec, s[94:95]
    buffer_store_dwordx4 v[84:87], v28, s[12:15], s26 offen offset:0 sc1
    s_mov_b64 exec, s[94:95]
    s_cbranch_execz PC4
    buffer_store_dwordx2 v[84:85], v28, s[12:15], s26 offen offset:0 sc1
    buffer_store_dwordx2 v[86:87], v29, s[12:15], s26 offen offset:0 sc1
PC4:
    s_mov_b64 exec, -1
    v_cvt_pk_bf16_f32 v88, v224, v225
    v_cvt_pk_bf16_f32 v89, v226, v227
    v_cvt_pk_bf16_f32 v90, v228, v229
    v_cvt_pk_bf16_f32 v91, v230, v231
    v_cvt_pk_bf16_f32 v92, v232, v233
    v_cvt_pk_bf16_f32 v93, v234, v235
    v_cvt_pk_bf16_f32 v94, v236, v237
    v_cvt_pk_bf16_f32 v95, v238, v239
    s_not_b64 exec, s[92:93]
    buffer_store_dwordx4 v[88:91], v26, s[12:15], s27 offen offset:0 sc1
    s_mov_b64 exec, s[92:93]
    s_cbranch_execz PC5
    buffer_store_dwordx2 v[88:89], v26, s[12:15], s27 offen offset:0 sc1
    buffer_store_dwordx2 v[90:91], v27, s[12:15], s27 offen offset:0 sc1
PC5:
    s_not_b64 exec, s[94:95]
    buffer_store_dwordx4 v[92:95], v28, s[12:15], s27 offen offset:0 sc1
    s_mov_b64 exec, s[94:95]
    s_cbranch_execz PC6
    buffer_store_dwordx2 v[92:93], v28, s[12:15], s27 offen offset:0 sc1
    buffer_store_dwordx2 v[94:95], v29, s[12:15], s27 offen offset:0 sc1
PC6:
    s_mov_b64 exec, -1
    v_pk_mul_f32 v[160:161], v[160:161], s[30:31]
    v_pk_mul_f32 v[162:163], v[162:163], s[30:31]
    v_pk_mul_f32 v[164:165], v[164:165], s[30:31]
    v_pk_mul_f32 v[166:167], v[166:167], s[30:31]
    v_pk_mul_f32 v[168:169], v[168:169], s[30:31]
    v_pk_mul_f32 v[170:171], v[170:171], s[30:31]
    v_pk_mul_f32 v[172:173], v[172:173], s[30:31]
    v_pk_mul_f32 v[174:175], v[174:175], s[30:31]
    v_cvt_pk_bf16_f32 v96, v160, v161
    v_cvt_pk_bf16_f32 v97, v162, v163
    v_cvt_pk_bf16_f32 v98, v164, v165
    v_cvt_pk_bf16_f32 v99, v166, v167
    v_cvt_pk_bf16_f32 v100, v168, v169
    v_cvt_pk_bf16_f32 v101, v170, v171
    v_cvt_pk_bf16_f32 v102, v172, v173
    v_cvt_pk_bf16_f32 v103, v174, v175
    s_not_b64 exec, s[92:93]
    buffer_store_dwordx4 v[96:99], v22, s[12:15], s25 offen offset:0 sc1
    s_mov_b64 exec, s[92:93]
    s_cbranch_execz PC7
    buffer_store_dwordx2 v[96:97], v22, s[12:15], s25 offen offset:0 sc1
    buffer_store_dwordx2 v[98:99], v23, s[12:15], s25 offen offset:0 sc1
PC7:
    s_not_b64 exec, s[94:95]
    buffer_store_dwordx4 v[100:103], v24, s[12:15], s25 offen offset:0 sc1
    s_mov_b64 exec, s[94:95]
    s_cbranch_execz PC8
    buffer_store_dwordx2 v[100:101], v24, s[12:15], s25 offen offset:0 sc1
    buffer_store_dwordx2 v[102:103], v25, s[12:15], s25 offen offset:0 sc1
PC8:
    s_mov_b64 exec, -1
    v_pk_mul_f32 v[208:209], v[208:209], s[30:31]
    v_pk_mul_f32 v[210:211], v[210:211], s[30:31]
    v_pk_mul_f32 v[212:213], v[212:213], s[30:31]
    v_pk_mul_f32 v[214:215], v[214:215], s[30:31]
    v_pk_mul_f32 v[216:217], v[216:217], s[30:31]
    v_pk_mul_f32 v[218:219], v[218:219], s[30:31]
    v_pk_mul_f32 v[220:221], v[220:221], s[30:31]
    v_pk_mul_f32 v[222:223], v[222:223], s[30:31]
    v_cvt_pk_bf16_f32 v104, v208, v209
    v_cvt_pk_bf16_f32 v105, v210, v211
    v_cvt_pk_bf16_f32 v106, v212, v213
    v_cvt_pk_bf16_f32 v107, v214, v215
    v_cvt_pk_bf16_f32 v108, v216, v217
    v_cvt_pk_bf16_f32 v109, v218, v219
    v_cvt_pk_bf16_f32 v110, v220, v221
    v_cvt_pk_bf16_f32 v111, v222, v223
    s_not_b64 exec, s[92:93]
    buffer_store_dwordx4 v[104:107], v22, s[12:15], s25 offen offset:2048 sc1
    s_mov_b64 exec, s[92:93]
    s_cbranch_execz PC9
    buffer_store_dwordx2 v[104:105], v22, s[12:15], s25 offen offset:2048 sc1
    buffer_store_dwordx2 v[106:107], v23, s[12:15], s25 offen offset:2048 sc1
PC9:
    s_not_b64 exec, s[94:95]
    buffer_store_dwordx4 v[108:111], v24, s[12:15], s25 offen offset:2048 sc1
    s_mov_b64 exec, s[94:95]
    s_cbranch_execz PC10
    buffer_store_dwordx2 v[108:109], v24, s[12:15], s25 offen offset:2048 sc1
    buffer_store_dwordx2 v[110:111], v25, s[12:15], s25 offen offset:2048 sc1
PC10:
    s_mov_b64 exec, -1
    s_branch L_P1DONE
L_P1B:
    s_barrier
    ds_read_b128 v[64:67], v10 offset:40960
    ds_read_b128 v[68:71], v10 offset:45056
    ds_read_b64_tr_b16 v[72:73], v14 offset:40960
    ds_read_b64_tr_b16 v[74:75], v14 offset:41472
    ds_read_b64_tr_b16 v[76:77], v14 offset:49152
    ds_read_b64_tr_b16 v[78:79], v14 offset:49664
    ds_read_b64_tr_b16 v[80:81], v14 offset:57344
    ds_read_b64_tr_b16 v[82:83], v14 offset:57856
    s_waitcnt lgkmcnt(0)
    v_mfma_f32_32x32x16_bf16 v[192:207], v[64:67], v[80:83], v[192:207]
    ds_read_b128 v[84:87], v11 offset:40960
    ds_read_b128 v[88:91], v11 offset:45056
    v_mfma_f32_32x32x16_bf16 v[240:255], v[68:71], v[80:83], v[240:255]
    ds_read_b64_tr_b16 v[92:93], v14 offset:43008
    ds_read_b64_tr_b16 v[94:95], v14 offset:43520
    v_mfma_f32_32x32x16_bf16 v[176:191], v[64:67], v[76:79], v[176:191]
    ds_read_b64_tr_b16 v[96:97], v14 offset:51200
    ds_read_b64_tr_b16 v[98:99], v14 offset:51712
    v_mfma_f32_32x32x16_bf16 v[224:239], v[68:71], v[76:79], v[224:239]
    ds_read_b64_tr_b16 v[100:101], v14 offset:59392
    ds_read_b64_tr_b16 v[102:103], v14 offset:59904
    v_mfma_f32_32x32x16_bf16 v[160:175], v[72:75], v[64:67], v[160:175]
    v_mfma_f32_32x32x16_bf16 v[208:223], v[72:75], v[68:71], v[208:223]
    s_waitcnt lgkmcnt(0)
    v_mfma_f32_32x32x16_bf16 v[192:207], v[84:87], v[100:103], v[192:207]
    ds_read_b128 v[64:67], v12 offset:40960
    ds_read_b128 v[68:71], v12 offset:45056
    v_mfma_f32_32x32x16_bf16 v[240:255], v[88:91], v[100:103], v[240:255]
    ds_read_b64_tr_b16 v[72:73], v14 offset:45056
    ds_read_b64_tr_b16 v[74:75], v14 offset:45568
    v_mfma_f32_32x32x16_bf16 v[176:191], v[84:87], v[96:99], v[176:191]
    ds_read_b64_tr_b16 v[76:77], v14 offset:53248
    ds_read_b64_tr_b16 v[78:79], v14 offset:53760
    v_mfma_f32_32x32x16_bf16 v[224:239], v[88:91], v[96:99], v[224:239]
    ds_read_b64_tr_b16 v[80:81], v14 offset:61440
    ds_read_b64_tr_b16 v[82:83], v14 offset:61952
    v_mfma_f32_32x32x16_bf16 v[160:175], v[92:95], v[84:87], v[160:175]
    v_mfma_f32_32x32x16_bf16 v[208:223], v[92:95], v[88:91], v[208:223]
    s_waitcnt lgkmcnt(0)
    v_mfma_f32_32x32x16_bf16 v[192:207], v[64:67], v[80:83], v[192:207]
    ds_read_b128 v[84:87], v13 offset:40960
    ds_read_b128 v[88:91], v13 offset:45056
    v_mfma_f32_32x32x16_bf16 v[240:255], v[68:71], v[80:83], v[240:255]
    ds_read_b64_tr_b16 v[92:93], v14 offset:47104
    ds_read_b64_tr_b16 v[94:95], v14 offset:47616
    v_mfma_f32_32x32x16_bf16 v[176:191], v[64:67], v[76:79], v[176:191]
    ds_read_b64_tr_b16 v[96:97], v14 offset:55296
    ds_read_b64_tr_b16 v[98:99], v14 offset:55808
    v_mfma_f32_32x32x16_bf16 v[224:239], v[68:71], v[76:79], v[224:239]
    ds_read_b64_tr_b16 v[100:101], v14 offset:63488
    ds_read_b64_tr_b16 v[102:103], v14 offset:64000
    v_mfma_f32_32x32x16_bf16 v[160:175], v[72:75], v[64:67], v[160:175]
    v_mfma_f32_32x32x16_bf16 v[208:223], v[72:75], v[68:71], v[208:223]
    s_waitcnt lgkmcnt(0)
    s_barrier
    v_mfma_f32_32x32x16_bf16 v[192:207], v[84:87], v[100:103], v[192:207]
    ds_read_b128 v[64:67], v16 offset:0
    ds_read_b128 v[68:71], v16 offset:4096
    v_mfma_f32_32x32x16_bf16 v[240:255], v[88:91], v[100:103], v[240:255]
    ds_read_b64_tr_b16 v[72:73], v15 offset:0
    ds_read_b64_tr_b16 v[74:75], v15 offset:512
    v_mfma_f32_32x32x16_bf16 v[176:191], v[84:87], v[96:99], v[176:191]
    ds_read_b64_tr_b16 v[76:77], v15 offset:8192
    ds_read_b64_tr_b16 v[78:79], v15 offset:8704
    v_mfma_f32_32x32x16_bf16 v[224:239], v[88:91], v[96:99], v[224:239]
    ds_read_b64_tr_b16 v[80:81], v15 offset:16384
    ds_read_b64_tr_b16 v[82:83], v15 offset:16896
    v_mfma_f32_32x32x16_bf16 v[160:175], v[92:95], v[84:87], v[160:175]
    v_mfma_f32_32x32x16_bf16 v[208:223], v[92:95], v[88:91], v[208:223]
    s_waitcnt lgkmcnt(0)
    v_mfma_f32_32x32x16_bf16 v[192:207], v[64:67], v[80:83], v[192:207]
    ds_read_b128 v[84:87], v17 offset:0
    ds_read_b128 v[88:91], v17 offset:4096
    v_mfma_f32_32x32x16_bf16 v[240:255], v[68:71], v[80:83], v[240:255]
    ds_read_b64_tr_b16 v[92:93], v15 offset:2048
    ds_read_b64_tr_b16 v[94:95], v15 offset:2560
    v_mfma_f32_32x32x16_bf16 v[176:191], v[64:67], v[76:79], v[176:191]
    ds_read_b64_tr_b16 v[96:97], v15 offset:10240
    ds_read_b64_tr_b16 v[98:99], v15 offset:10752
    v_mfma_f32_32x32x16_bf16 v[224:239], v[68:71], v[76:79], v[224:239]
    ds_read_b64_tr_b16 v[100:101], v15 offset:18432
    ds_read_b64_tr_b16 v[102:103], v15 offset:18944
    v_mfma_f32_32x32x16_bf16 v[160:175], v[72:75], v[64:67], v[160:175]
    v_mfma_f32_32x32x16_bf16 v[208:223], v[72:75], v[68:71], v[208:223]
    s_waitcnt lgkmcnt(0)
    v_mfma_f32_32x32x16_bf16 v[192:207], v[84:87], v[100:103], v[192:207]
    ds_read_b128 v[64:67], v18 offset:0
    ds_read_b128 v[68:71], v18 offset:4096
    v_mfma_f32_32x32x16_bf16 v[240:255], v[88:91], v[100:103], v[240:255]
    ds_read_b64_tr_b16 v[72:73], v15 offset:4096
    ds_read_b64_tr_b16 v[74:75], v15 offset:4608
    v_mfma_f32_32x32x16_bf16 v[176:191], v[84:87], v[96:99], v[176:191]
    ds_read_b64_tr_b16 v[76:77], v15 offset:12288
    ds_read_b64_tr_b16 v[78:79], v15 offset:12800
    v_mfma_f32_32x32x16_bf16 v[224:239], v[88:91], v[96:99], v[224:239]
    ds_read_b64_tr_b16 v[80:81], v15 offset:20480
    ds_read_b64_tr_b16 v[82:83], v15 offset:20992
    v_mfma_f32_32x32x16_bf16 v[160:175], v[92:95], v[84:87], v[160:175]
    v_mfma_f32_32x32x16_bf16 v[208:223], v[92:95], v[88:91], v[208:223]
    s_waitcnt lgkmcnt(0)
    v_mfma_f32_32x32x16_bf16 v[192:207], v[64:67], v[80:83], v[192:207]
    ds_read_b128 v[84:87], v19 offset:0
    ds_read_b128 v[88:91], v19 offset:4096
    v_mfma_f32_32x32x16_bf16 v[240:255], v[68:71], v[80:83], v[240:255]
    ds_read_b64_tr_b16 v[92:93], v15 offset:6144
    ds_read_b64_tr_b16 v[94:95], v15 offset:6656
    v_mfma_f32_32x32x16_bf16 v[176:191], v[64:67], v[76:79], v[176:191]
    ds_read_b64_tr_b16 v[96:97], v15 offset:14336
    ds_read_b64_tr_b16 v[98:99], v15 offset:14848
    v_mfma_f32_32x32x16_bf16 v[224:239], v[68:71], v[76:79], v[224:239]
    ds_read_b64_tr_b16 v[100:101], v15 offset:22528
    ds_read_b64_tr_b16 v[102:103], v15 offset:23040
    v_mfma_f32_32x32x16_bf16 v[160:175], v[72:75], v[64:67], v[160:175]
    v_mfma_f32_32x32x16_bf16 v[208:223], v[72:75], v[68:71], v[208:223]
    s_waitcnt lgkmcnt(0)
    s_barrier
    v_mfma_f32_32x32x16_bf16 v[192:207], v[84:87], v[100:103], v[192:207]
    ds_read_b128 v[64:67], v16 offset:40960
    ds_read_b128 v[68:71], v16 offset:45056
    v_mfma_f32_32x32x16_bf16 v[240:255], v[88:91], v[100:103], v[240:255]
    ds_read_b64_tr_b16 v[72:73], v15 offset:40960
    ds_read_b64_tr_b16 v[74:75], v15 offset:41472
    v_mfma_f32_32x32x16_bf16 v[176:191], v[84:87], v[96:99], v[176:191]
    ds_read_b64_tr_b16 v[76:77], v15 offset:49152
    ds_read_b64_tr_b16 v[78:79], v15 offset:49664
    v_mfma_f32_32x32x16_bf16 v[224:239], v[88:91], v[96:99], v[224:239]
    ds_read_b64_tr_b16 v[80:81], v15 offset:57344
    ds_read_b64_tr_b16 v[82:83], v15 offset:57856
    v_mfma_f32_32x32x16_bf16 v[160:175], v[92:95], v[84:87], v[160:175]
    v_mfma_f32_32x32x16_bf16 v[208:223], v[92:95], v[88:91], v[208:223]
    s_waitcnt lgkmcnt(0)
    v_mfma_f32_32x32x16_bf16 v[192:207], v[64:67], v[80:83], v[192:207]
    ds_read_b128 v[84:87], v17 offset:40960
    ds_read_b128 v[88:91], v17 offset:45056
    v_mfma_f32_32x32x16_bf16 v[240:255], v[68:71], v[80:83], v[240:255]
    ds_read_b64_tr_b16 v[92:93], v15 offset:43008
    ds_read_b64_tr_b16 v[94:95], v15 offset:43520
    v_mfma_f32_32x32x16_bf16 v[176:191], v[64:67], v[76:79], v[176:191]
    ds_read_b64_tr_b16 v[96:97], v15 offset:51200
    ds_read_b64_tr_b16 v[98:99], v15 offset:51712
    v_mfma_f32_32x32x16_bf16 v[224:239], v[68:71], v[76:79], v[224:239]
    ds_read_b64_tr_b16 v[100:101], v15 offset:59392
    ds_read_b64_tr_b16 v[102:103], v15 offset:59904
    v_mfma_f32_32x32x16_bf16 v[160:175], v[72:75], v[64:67], v[160:175]
    v_mfma_f32_32x32x16_bf16 v[208:223], v[72:75], v[68:71], v[208:223]
    s_waitcnt lgkmcnt(0)
    v_mfma_f32_32x32x16_bf16 v[192:207], v[84:87], v[100:103], v[192:207]
    ds_read_b128 v[64:67], v18 offset:40960
    ds_read_b128 v[68:71], v18 offset:45056
    v_mfma_f32_32x32x16_bf16 v[240:255], v[88:91], v[100:103], v[240:255]
    ds_read_b64_tr_b16 v[72:73], v15 offset:45056
    ds_read_b64_tr_b16 v[74:75], v15 offset:45568
    v_mfma_f32_32x32x16_bf16 v[176:191], v[84:87], v[96:99], v[176:191]
    ds_read_b64_tr_b16 v[76:77], v15 offset:53248
    ds_read_b64_tr_b16 v[78:79], v15 offset:53760
    v_mfma_f32_32x32x16_bf16 v[224:239], v[88:91], v[96:99], v[224:239]
    ds_read_b64_tr_b16 v[80:81], v15 offset:61440
    ds_read_b64_tr_b16 v[82:83], v15 offset:61952
    v_mfma_f32_32x32x16_bf16 v[160:175], v[92:95], v[84:87], v[160:175]
    v_mfma_f32_32x32x16_bf16 v[208:223], v[92:95], v[88:91], v[208:223]
    s_waitcnt lgkmcnt(0)
    v_mfma_f32_32x32x16_bf16 v[192:207], v[64:67], v[80:83], v[192:207]
    ds_read_b128 v[84:87], v19 offset:40960
    ds_read_b128 v[88:91], v19 offset:45056
    v_mfma_f32_32x32x16_bf16 v[240:255], v[68:71], v[80:83], v[240:255]
    ds_read_b64_tr_b16 v[92:93], v15 offset:47104
    ds_read_b64_tr_b16 v[94:95], v15 offset:47616
    v_mfma_f32_32x32x16_bf16 v[176:191], v[64:67], v[76:79], v[176:191]
    ds_read_b64_tr_b16 v[96:97], v15 offset:55296
    ds_read_b64_tr_b16 v[98:99], v15 offset:55808
    v_mfma_f32_32x32x16_bf16 v[224:239], v[68:71], v[76:79], v[224:239]
    ds_read_b64_tr_b16 v[100:101], v15 offset:63488
    ds_read_b64_tr_b16 v[102:103], v15 offset:64000
    v_mfma_f32_32x32x16_bf16 v[160:175], v[72:75], v[64:67], v[160:175]
    v_mfma_f32_32x32x16_bf16 v[208:223], v[72:75], v[68:71], v[208:223]
    s_waitcnt lgkmcnt(0)
    s_barrier
    v_mfma_f32_32x32x16_bf16 v[192:207], v[84:87], v[100:103], v[192:207]
    ds_read_b128 v[64:67], v10 offset:0
    ds_read_b128 v[68:71], v10 offset:4096
    v_mfma_f32_32x32x16_bf16 v[240:255], v[88:91], v[100:103], v[240:255]
    ds_read_b64_tr_b16 v[72:73], v14 offset:0
    ds_read_b64_tr_b16 v[74:75], v14 offset:512
    v_mfma_f32_32x32x16_bf16 v[176:191], v[84:87], v[96:99], v[176:191]
    ds_read_b64_tr_b16 v[76:77], v14 offset:8192
    ds_read_b64_tr_b16 v[78:79], v14 offset:8704
    v_mfma_f32_32x32x16_bf16 v[224:239], v[88:91], v[96:99], v[224:239]
    ds_read_b64_tr_b16 v[80:81], v14 offset:16384
    ds_read_b64_tr_b16 v[82:83], v14 offset:16896
    v_mfma_f32_32x32x16_bf16 v[160:175], v[92:95], v[84:87], v[160:175]
    v_mfma_f32_32x32x16_bf16 v[208:223], v[92:95], v[88:91], v[208:223]
    s_waitcnt lgkmcnt(0)
    v_mfma_f32_32x32x16_bf16 v[192:207], v[64:67], v[80:83], v[192:207]
    ds_read_b128 v[84:87], v11 offset:0
    ds_read_b128 v[88:91], v11 offset:4096
    v_mfma_f32_32x32x16_bf16 v[240:255], v[68:71], v[80:83], v[240:255]
    ds_read_b64_tr_b16 v[92:93], v14 offset:2048
    ds_read_b64_tr_b16 v[94:95], v14 offset:2560
    v_mfma_f32_32x32x16_bf16 v[176:191], v[64:67], v[76:79], v[176:191]
    ds_read_b64_tr_b16 v[96:97], v14 offset:10240
    ds_read_b64_tr_b16 v[98:99], v14 offset:10752
    v_mfma_f32_32x32x16_bf16 v[224:239], v[68:71], v[76:79], v[224:239]
    ds_read_b64_tr_b16 v[100:101], v14 offset:18432
    ds_read_b64_tr_b16 v[102:103], v14 offset:18944
    v_mfma_f32_32x32x16_bf16 v[160:175], v[72:75], v[64:67], v[160:175]
    v_mfma_f32_32x32x16_bf16 v[208:223], v[72:75], v[68:71], v[208:223]
    s_waitcnt lgkmcnt(0)
    v_mfma_f32_32x32x16_bf16 v[192:207], v[84:87], v[100:103], v[192:207]
    ds_read_b128 v[64:67], v12 offset:0
    ds_read_b128 v[68:71], v12 offset:4096
    v_mfma_f32_32x32x16_bf16 v[240:255], v[88:91], v[100:103], v[240:255]
    ds_read_b64_tr_b16 v[72:73], v14 offset:4096
    ds_read_b64_tr_b16 v[74:75], v14 offset:4608
    v_mfma_f32_32x32x16_bf16 v[176:191], v[84:87], v[96:99], v[176:191]
    ds_read_b64_tr_b16 v[76:77], v14 offset:12288
    ds_read_b64_tr_b16 v[78:79], v14 offset:12800
    v_mfma_f32_32x32x16_bf16 v[224:239], v[88:91], v[96:99], v[224:239]
    ds_read_b64_tr_b16 v[80:81], v14 offset:20480
    ds_read_b64_tr_b16 v[82:83], v14 offset:20992
    v_mfma_f32_32x32x16_bf16 v[160:175], v[92:95], v[84:87], v[160:175]
    v_mfma_f32_32x32x16_bf16 v[208:223], v[92:95], v[88:91], v[208:223]
    s_waitcnt lgkmcnt(0)
    v_mfma_f32_32x32x16_bf16 v[192:207], v[64:67], v[80:83], v[192:207]
    ds_read_b128 v[84:87], v13 offset:0
    ds_read_b128 v[88:91], v13 offset:4096
    v_mfma_f32_32x32x16_bf16 v[240:255], v[68:71], v[80:83], v[240:255]
    ds_read_b64_tr_b16 v[92:93], v14 offset:6144
    ds_read_b64_tr_b16 v[94:95], v14 offset:6656
    v_mfma_f32_32x32x16_bf16 v[176:191], v[64:67], v[76:79], v[176:191]
    ds_read_b64_tr_b16 v[96:97], v14 offset:14336
    ds_read_b64_tr_b16 v[98:99], v14 offset:14848
    v_mfma_f32_32x32x16_bf16 v[224:239], v[68:71], v[76:79], v[224:239]
    ds_read_b64_tr_b16 v[100:101], v14 offset:22528
    ds_read_b64_tr_b16 v[102:103], v14 offset:23040
    v_mfma_f32_32x32x16_bf16 v[160:175], v[72:75], v[64:67], v[160:175]
    v_mfma_f32_32x32x16_bf16 v[208:223], v[72:75], v[68:71], v[208:223]
    s_waitcnt lgkmcnt(0)
    s_barrier
    v_mfma_f32_32x32x16_bf16 v[192:207], v[84:87], v[100:103], v[192:207]
    ds_read_b128 v[64:67], v10 offset:40960
    ds_read_b128 v[68:71], v10 offset:45056
    v_mfma_f32_32x32x16_bf16 v[240:255], v[88:91], v[100:103], v[240:255]
    ds_read_b64_tr_b16 v[72:73], v14 offset:40960
    ds_read_b64_tr_b16 v[74:75], v14 offset:41472
    v_mfma_f32_32x32x16_bf16 v[176:191], v[84:87], v[96:99], v[176:191]
    ds_read_b64_tr_b16 v[76:77], v14 offset:49152
    ds_read_b64_tr_b16 v[78:79], v14 offset:49664
    v_mfma_f32_32x32x16_bf16 v[224:239], v[88:91], v[96:99], v[224:239]
    ds_read_b64_tr_b16 v[80:81], v14 offset:57344
    ds_read_b64_tr_b16 v[82:83], v14 offset:57856
    v_mfma_f32_32x32x16_bf16 v[160:175], v[92:95], v[84:87], v[160:175]
    v_mfma_f32_32x32x16_bf16 v[208:223], v[92:95], v[88:91], v[208:223]
    s_waitcnt lgkmcnt(0)
    v_mfma_f32_32x32x16_bf16 v[192:207], v[64:67], v[80:83], v[192:207]
    ds_read_b128 v[84:87], v11 offset:40960
    ds_read_b128 v[88:91], v11 offset:45056
    v_mfma_f32_32x32x16_bf16 v[240:255], v[68:71], v[80:83], v[240:255]
    ds_read_b64_tr_b16 v[92:93], v14 offset:43008
    ds_read_b64_tr_b16 v[94:95], v14 offset:43520
    v_mfma_f32_32x32x16_bf16 v[176:191], v[64:67], v[76:79], v[176:191]
    ds_read_b64_tr_b16 v[96:97], v14 offset:51200
    ds_read_b64_tr_b16 v[98:99], v14 offset:51712
    v_mfma_f32_32x32x16_bf16 v[224:239], v[68:71], v[76:79], v[224:239]
    ds_read_b64_tr_b16 v[100:101], v14 offset:59392
    ds_read_b64_tr_b16 v[102:103], v14 offset:59904
    v_mfma_f32_32x32x16_bf16 v[160:175], v[72:75], v[64:67], v[160:175]
    v_mfma_f32_32x32x16_bf16 v[208:223], v[72:75], v[68:71], v[208:223]
    s_waitcnt lgkmcnt(0)
    v_mfma_f32_32x32x16_bf16 v[192:207], v[84:87], v[100:103], v[192:207]
    ds_read_b128 v[64:67], v12 offset:40960
    ds_read_b128 v[68:71], v12 offset:45056
    v_mfma_f32_32x32x16_bf16 v[240:255], v[88:91], v[100:103], v[240:255]
    ds_read_b64_tr_b16 v[72:73], v14 offset:45056
    ds_read_b64_tr_b16 v[74:75], v14 offset:45568
    v_mfma_f32_32x32x16_bf16 v[176:191], v[84:87], v[96:99], v[176:191]
    ds_read_b64_tr_b16 v[76:77], v14 offset:53248
    ds_read_b64_tr_b16 v[78:79], v14 offset:53760
    v_mfma_f32_32x32x16_bf16 v[224:239], v[88:91], v[96:99], v[224:239]
    ds_read_b64_tr_b16 v[80:81], v14 offset:61440
    ds_read_b64_tr_b16 v[82:83], v14 offset:61952
    v_mfma_f32_32x32x16_bf16 v[160:175], v[92:95], v[84:87], v[160:175]
    v_mfma_f32_32x32x16_bf16 v[208:223], v[92:95], v[88:91], v[208:223]
    s_waitcnt lgkmcnt(0)
    v_mfma_f32_32x32x16_bf16 v[192:207], v[64:67], v[80:83], v[192:207]
    ds_read_b128 v[84:87], v13 offset:40960
    ds_read_b128 v[88:91], v13 offset:45056
    v_mfma_f32_32x32x16_bf16 v[240:255], v[68:71], v[80:83], v[240:255]
    ds_read_b64_tr_b16 v[92:93], v14 offset:47104
    ds_read_b64_tr_b16 v[94:95], v14 offset:47616
    v_mfma_f32_32x32x16_bf16 v[176:191], v[64:67], v[76:79], v[176:191]
    ds_read_b64_tr_b16 v[96:97], v14 offset:55296
    ds_read_b64_tr_b16 v[98:99], v14 offset:55808
    v_mfma_f32_32x32x16_bf16 v[224:239], v[68:71], v[76:79], v[224:239]
    ds_read_b64_tr_b16 v[100:101], v14 offset:63488
    ds_read_b64_tr_b16 v[102:103], v14 offset:64000
    v_mfma_f32_32x32x16_bf16 v[160:175], v[72:75], v[64:67], v[160:175]
    v_mfma_f32_32x32x16_bf16 v[208:223], v[72:75], v[68:71], v[208:223]
    s_waitcnt lgkmcnt(0)
    s_barrier
    v_mfma_f32_32x32x16_bf16 v[192:207], v[84:87], v[100:103], v[192:207]
    ds_read_b128 v[64:67], v16 offset:0
    ds_read_b128 v[68:71], v16 offset:4096
    v_mfma_f32_32x32x16_bf16 v[240:255], v[88:91], v[100:103], v[240:255]
    ds_read_b64_tr_b16 v[72:73], v15 offset:0
    ds_read_b64_tr_b16 v[74:75], v15 offset:512
    v_mfma_f32_32x32x16_bf16 v[176:191], v[84:87], v[96:99], v[176:191]
    ds_read_b64_tr_b16 v[76:77], v15 offset:8192
    ds_read_b64_tr_b16 v[78:79], v15 offset:8704
    v_mfma_f32_32x32x16_bf16 v[224:239], v[88:91], v[96:99], v[224:239]
    ds_read_b64_tr_b16 v[80:81], v15 offset:16384
    ds_read_b64_tr_b16 v[82:83], v15 offset:16896
    v_mfma_f32_32x32x16_bf16 v[160:175], v[92:95], v[84:87], v[160:175]
    v_mfma_f32_32x32x16_bf16 v[208:223], v[92:95], v[88:91], v[208:223]
    s_waitcnt lgkmcnt(0)
    v_mfma_f32_32x32x16_bf16 v[192:207], v[64:67], v[80:83], v[192:207]
    ds_read_b128 v[84:87], v17 offset:0
    ds_read_b128 v[88:91], v17 offset:4096
    v_mfma_f32_32x32x16_bf16 v[240:255], v[68:71], v[80:83], v[240:255]
    ds_read_b64_tr_b16 v[92:93], v15 offset:2048
    ds_read_b64_tr_b16 v[94:95], v15 offset:2560
    v_mfma_f32_32x32x16_bf16 v[176:191], v[64:67], v[76:79], v[176:191]
    ds_read_b64_tr_b16 v[96:97], v15 offset:10240
    ds_read_b64_tr_b16 v[98:99], v15 offset:10752
    v_mfma_f32_32x32x16_bf16 v[224:239], v[68:71], v[76:79], v[224:239]
    ds_read_b64_tr_b16 v[100:101], v15 offset:18432
    ds_read_b64_tr_b16 v[102:103], v15 offset:18944
    v_mfma_f32_32x32x16_bf16 v[160:175], v[72:75], v[64:67], v[160:175]
    v_mfma_f32_32x32x16_bf16 v[208:223], v[72:75], v[68:71], v[208:223]
    s_waitcnt lgkmcnt(0)
    v_mfma_f32_32x32x16_bf16 v[192:207], v[84:87], v[100:103], v[192:207]
    ds_read_b128 v[64:67], v18 offset:0
    ds_read_b128 v[68:71], v18 offset:4096
    v_mfma_f32_32x32x16_bf16 v[240:255], v[88:91], v[100:103], v[240:255]
    ds_read_b64_tr_b16 v[72:73], v15 offset:4096
    ds_read_b64_tr_b16 v[74:75], v15 offset:4608
    v_mfma_f32_32x32x16_bf16 v[176:191], v[84:87], v[96:99], v[176:191]
    ds_read_b64_tr_b16 v[76:77], v15 offset:12288
    ds_read_b64_tr_b16 v[78:79], v15 offset:12800
    v_mfma_f32_32x32x16_bf16 v[224:239], v[88:91], v[96:99], v[224:239]
    ds_read_b64_tr_b16 v[80:81], v15 offset:20480
    ds_read_b64_tr_b16 v[82:83], v15 offset:20992
    v_mfma_f32_32x32x16_bf16 v[160:175], v[92:95], v[84:87], v[160:175]
    v_mfma_f32_32x32x16_bf16 v[208:223], v[92:95], v[88:91], v[208:223]
    s_waitcnt lgkmcnt(0)
    v_mfma_f32_32x32x16_bf16 v[192:207], v[64:67], v[80:83], v[192:207]
    ds_read_b128 v[84:87], v19 offset:0
    ds_read_b128 v[88:91], v19 offset:4096
    v_mfma_f32_32x32x16_bf16 v[240:255], v[68:71], v[80:83], v[240:255]
    ds_read_b64_tr_b16 v[92:93], v15 offset:6144
    ds_read_b64_tr_b16 v[94:95], v15 offset:6656
    v_mfma_f32_32x32x16_bf16 v[176:191], v[64:67], v[76:79], v[176:191]
    ds_read_b64_tr_b16 v[96:97], v15 offset:14336
    ds_read_b64_tr_b16 v[98:99], v15 offset:14848
    v_mfma_f32_32x32x16_bf16 v[224:239], v[68:71], v[76:79], v[224:239]
    ds_read_b64_tr_b16 v[100:101], v15 offset:22528
    ds_read_b64_tr_b16 v[102:103], v15 offset:23040
    v_mfma_f32_32x32x16_bf16 v[160:175], v[72:75], v[64:67], v[160:175]
    v_mfma_f32_32x32x16_bf16 v[208:223], v[72:75], v[68:71], v[208:223]
    s_waitcnt lgkmcnt(0)
    s_barrier
    v_mfma_f32_32x32x16_bf16 v[192:207], v[84:87], v[100:103], v[192:207]
    ds_read_b128 v[64:67], v16 offset:40960
    ds_read_b128 v[68:71], v16 offset:45056
    v_mfma_f32_32x32x16_bf16 v[240:255], v[88:91], v[100:103], v[240:255]
    ds_read_b64_tr_b16 v[72:73], v15 offset:40960
    ds_read_b64_tr_b16 v[74:75], v15 offset:41472
    v_mfma_f32_32x32x16_bf16 v[176:191], v[84:87], v[96:99], v[176:191]
    ds_read_b64_tr_b16 v[76:77], v15 offset:49152
    ds_read_b64_tr_b16 v[78:79], v15 offset:49664
    v_mfma_f32_32x32x16_bf16 v[224:239], v[88:91], v[96:99], v[224:239]
    ds_read_b64_tr_b16 v[80:81], v15 offset:57344
    ds_read_b64_tr_b16 v[82:83], v15 offset:57856
    v_mfma_f32_32x32x16_bf16 v[160:175], v[92:95], v[84:87], v[160:175]
    v_mfma_f32_32x32x16_bf16 v[208:223], v[92:95], v[88:91], v[208:223]
    s_waitcnt lgkmcnt(0)
    v_mfma_f32_32x32x16_bf16 v[192:207], v[64:67], v[80:83], v[192:207]
    ds_read_b128 v[84:87], v17 offset:40960
    ds_read_b128 v[88:91], v17 offset:45056
    v_mfma_f32_32x32x16_bf16 v[240:255], v[68:71], v[80:83], v[240:255]
    ds_read_b64_tr_b16 v[92:93], v15 offset:43008
    ds_read_b64_tr_b16 v[94:95], v15 offset:43520
    v_mfma_f32_32x32x16_bf16 v[176:191], v[64:67], v[76:79], v[176:191]
    ds_read_b64_tr_b16 v[96:97], v15 offset:51200
    ds_read_b64_tr_b16 v[98:99], v15 offset:51712
    v_mfma_f32_32x32x16_bf16 v[224:239], v[68:71], v[76:79], v[224:239]
    ds_read_b64_tr_b16 v[100:101], v15 offset:59392
    ds_read_b64_tr_b16 v[102:103], v15 offset:59904
    v_mfma_f32_32x32x16_bf16 v[160:175], v[72:75], v[64:67], v[160:175]
    v_mfma_f32_32x32x16_bf16 v[208:223], v[72:75], v[68:71], v[208:223]
    s_waitcnt lgkmcnt(0)
    v_mfma_f32_32x32x16_bf16 v[192:207], v[84:87], v[100:103], v[192:207]
    ds_read_b128 v[64:67], v18 offset:40960
    ds_read_b128 v[68:71], v18 offset:45056
    v_mfma_f32_32x32x16_bf16 v[240:255], v[88:91], v[100:103], v[240:255]
    ds_read_b64_tr_b16 v[72:73], v15 offset:45056
    ds_read_b64_tr_b16 v[74:75], v15 offset:45568
    v_mfma_f32_32x32x16_bf16 v[176:191], v[84:87], v[96:99], v[176:191]
    ds_read_b64_tr_b16 v[76:77], v15 offset:53248
    ds_read_b64_tr_b16 v[78:79], v15 offset:53760
    v_mfma_f32_32x32x16_bf16 v[224:239], v[88:91], v[96:99], v[224:239]
    ds_read_b64_tr_b16 v[80:81], v15 offset:61440
    ds_read_b64_tr_b16 v[82:83], v15 offset:61952
    v_mfma_f32_32x32x16_bf16 v[160:175], v[92:95], v[84:87], v[160:175]
    v_mfma_f32_32x32x16_bf16 v[208:223], v[92:95], v[88:91], v[208:223]
    s_waitcnt lgkmcnt(0)
    v_mfma_f32_32x32x16_bf16 v[192:207], v[64:67], v[80:83], v[192:207]
    ds_read_b128 v[84:87], v19 offset:40960
    ds_read_b128 v[88:91], v19 offset:45056
    v_mfma_f32_32x32x16_bf16 v[240:255], v[68:71], v[80:83], v[240:255]
    ds_read_b64_tr_b16 v[92:93], v15 offset:47104
    ds_read_b64_tr_b16 v[94:95], v15 offset:47616
    v_mfma_f32_32x32x16_bf16 v[176:191], v[64:67], v[76:79], v[176:191]
    ds_read_b64_tr_b16 v[96:97], v15 offset:55296
    ds_read_b64_tr_b16 v[98:99], v15 offset:55808
    v_mfma_f32_32x32x16_bf16 v[224:239], v[68:71], v[76:79], v[224:239]
    ds_read_b64_tr_b16 v[100:101], v15 offset:63488
    ds_read_b64_tr_b16 v[102:103], v15 offset:64000
    v_mfma_f32_32x32x16_bf16 v[160:175], v[72:75], v[64:67], v[160:175]
    v_mfma_f32_32x32x16_bf16 v[208:223], v[72:75], v[68:71], v[208:223]
    s_waitcnt lgkmcnt(0)
    s_barrier
    v_mfma_f32_32x32x16_bf16 v[192:207], v[84:87], v[100:103], v[192:207]
    v_mfma_f32_32x32x16_bf16 v[240:255], v[88:91], v[100:103], v[240:255]
    v_mfma_f32_32x32x16_bf16 v[176:191], v[84:87], v[96:99], v[176:191]
    v_mfma_f32_32x32x16_bf16 v[224:239], v[88:91], v[96:99], v[224:239]
    v_mfma_f32_32x32x16_bf16 v[160:175], v[92:95], v[84:87], v[160:175]
    v_mfma_f32_32x32x16_bf16 v[208:223], v[92:95], v[88:91], v[208:223]
    v_and_b32 v37, 31, v2
    v_lshlrev_b32 v37, 2, v37
    buffer_load_dword v36, v37, s[52:55], 0 offen sc1
    s_mov_b32 s30, 1069066811
    s_mov_b32 s31, 1069066811
    s_mov_b32 s37, 897988541
    s_lshl_b32 s26, s19, 13
    s_add_u32 s26, s26, 114688
    v_add_u32 v5, s26, v1
    v_cvt_pk_bf16_f32 v72, v192, v193
    v_cvt_pk_bf16_f32 v73, v194, v195
    v_cvt_pk_bf16_f32 v74, v196, v197
    v_cvt_pk_bf16_f32 v75, v198, v199
    v_cvt_pk_bf16_f32 v76, v200, v201
    v_cvt_pk_bf16_f32 v77, v202, v203
    v_cvt_pk_bf16_f32 v78, v204, v205
    v_cvt_pk_bf16_f32 v79, v206, v207
    v_pk_mul_f32 v[112:113], v[176:177], s[30:31]
    v_pk_mul_f32 v[114:115], v[178:179], s[30:31]
    v_pk_mul_f32 v[116:117], v[180:181], s[30:31]
    v_pk_mul_f32 v[118:119], v[182:183], s[30:31]
    v_pk_mul_f32 v[120:121], v[184:185], s[30:31]
    v_pk_mul_f32 v[122:123], v[186:187], s[30:31]
    v_pk_mul_f32 v[124:125], v[188:189], s[30:31]
    v_pk_mul_f32 v[126:127], v[190:191], s[30:31]
    v_exp_f32 v112, v112 clamp
    v_exp_f32 v113, v113 clamp
    v_exp_f32 v114, v114 clamp
    v_exp_f32 v115, v115 clamp
    v_exp_f32 v116, v116 clamp
    v_exp_f32 v117, v117 clamp
    v_exp_f32 v118, v118 clamp
    v_exp_f32 v119, v119 clamp
    v_exp_f32 v120, v120 clamp
    v_exp_f32 v121, v121 clamp
    v_exp_f32 v122, v122 clamp
    v_exp_f32 v123, v123 clamp
    v_exp_f32 v124, v124 clamp
    v_exp_f32 v125, v125 clamp
    v_exp_f32 v126, v126 clamp
    v_exp_f32 v127, v127 clamp
    v_max_f32 v176, s37, v176
    v_max_f32 v177, s37, v177
    v_max_f32 v178, s37, v178
    v_max_f32 v179, s37, v179
    v_max_f32 v180, s37, v180
    v_max_f32 v181, s37, v181
    v_max_f32 v182, s37, v182
    v_max_f32 v183, s37, v183
    v_max_f32 v184, s37, v184
    v_max_f32 v185, s37, v185
    v_max_f32 v186, s37, v186
    v_max_f32 v187, s37, v187
    v_max_f32 v188, s37, v188
    v_max_f32 v189, s37, v189
    v_max_f32 v190, s37, v190
    v_max_f32 v191, s37, v191
    v_pk_add_f32 v[176:177], v[176:177], v[112:113]
    v_pk_add_f32 v[178:179], v[178:179], v[114:115]
    v_pk_add_f32 v[180:181], v[180:181], v[116:117]
    v_pk_add_f32 v[182:183], v[182:183], v[118:119]
    v_pk_add_f32 v[184:185], v[184:185], v[120:121]
    v_pk_add_f32 v[186:187], v[186:187], v[122:123]
    v_pk_add_f32 v[188:189], v[188:189], v[124:125]
    v_pk_add_f32 v[190:191], v[190:191], v[126:127]
    v_cvt_pk_bf16_f32 v64, v176, v177
    v_cvt_pk_bf16_f32 v65, v178, v179
    v_cvt_pk_bf16_f32 v66, v180, v181
    v_cvt_pk_bf16_f32 v67, v182, v183
    v_cvt_pk_bf16_f32 v68, v184, v185
    v_cvt_pk_bf16_f32 v69, v186, v187
    v_cvt_pk_bf16_f32 v70, v188, v189
    v_cvt_pk_bf16_f32 v71, v190, v191
    s_mov_b32 exec_lo, 0xf0000000
    s_mov_b32 exec_hi, 0xf0000000
    v_mov_b32 v72, 0x3f803f80
    v_mov_b32 v73, 0x3f803f80
    v_mov_b32 v74, 0x3f803f80
    v_mov_b32 v75, 0x3f803f80
    v_mov_b32 v76, 0x3f803f80
    v_mov_b32 v77, 0x3f803f80
    v_mov_b32 v78, 0x3f803f80
    v_mov_b32 v79, 0x3f803f80
    v_mov_b32 v64, 0
    v_mov_b32 v65, 0
    v_mov_b32 v66, 0
    v_mov_b32 v67, 0
    v_mov_b32 v68, 0
    v_mov_b32 v69, 0
    v_mov_b32 v70, 0
    v_mov_b32 v71, 0
    s_mov_b64 exec, -1
    v_mfma_f32_32x32x16_bf16 v[144:159], v[64:67], v[72:75], 0
    v_mfma_f32_32x32x16_bf16 v[144:159], v[68:71], v[76:79], v[144:159]
    v_cvt_pk_bf16_f32 v88, v240, v241
    v_cvt_pk_bf16_f32 v89, v242, v243
    v_cvt_pk_bf16_f32 v90, v244, v245
    v_cvt_pk_bf16_f32 v91, v246, v247
    v_cvt_pk_bf16_f32 v92, v248, v249
    v_cvt_pk_bf16_f32 v93, v250, v251
    v_cvt_pk_bf16_f32 v94, v252, v253
    v_cvt_pk_bf16_f32 v95, v254, v255
    v_pk_mul_f32 v[112:113], v[224:225], s[30:31]
    v_pk_mul_f32 v[114:115], v[226:227], s[30:31]
    v_pk_mul_f32 v[116:117], v[228:229], s[30:31]
    v_pk_mul_f32 v[118:119], v[230:231], s[30:31]
    v_pk_mul_f32 v[120:121], v[232:233], s[30:31]
    v_pk_mul_f32 v[122:123], v[234:235], s[30:31]
    v_pk_mul_f32 v[124:125], v[236:237], s[30:31]
    v_pk_mul_f32 v[126:127], v[238:239], s[30:31]
    v_exp_f32 v112, v112 clamp
    v_exp_f32 v113, v113 clamp
    v_exp_f32 v114, v114 clamp
    v_exp_f32 v115, v115 clamp
    v_exp_f32 v116, v116 clamp
    v_exp_f32 v117, v117 clamp
    v_exp_f32 v118, v118 clamp
    v_exp_f32 v119, v119 clamp
    v_exp_f32 v120, v120 clamp
    v_exp_f32 v121, v121 clamp
    v_exp_f32 v122, v122 clamp
    v_exp_f32 v123, v123 clamp
    v_exp_f32 v124, v124 clamp
    v_exp_f32 v125, v125 clamp
    v_exp_f32 v126, v126 clamp
    v_exp_f32 v127, v127 clamp
    v_max_f32 v224, s37, v224
    v_max_f32 v225, s37, v225
    v_max_f32 v226, s37, v226
    v_max_f32 v227, s37, v227
    v_max_f32 v228, s37, v228
    v_max_f32 v229, s37, v229
    v_max_f32 v230, s37, v230
    v_max_f32 v231, s37, v231
    v_max_f32 v232, s37, v232
    v_max_f32 v233, s37, v233
    v_max_f32 v234, s37, v234
    v_max_f32 v235, s37, v235
    v_max_f32 v236, s37, v236
    v_max_f32 v237, s37, v237
    v_max_f32 v238, s37, v238
    v_max_f32 v239, s37, v239
    v_pk_add_f32 v[224:225], v[224:225], v[112:113]
    v_pk_add_f32 v[226:227], v[226:227], v[114:115]
    v_pk_add_f32 v[228:229], v[228:229], v[116:117]
    v_pk_add_f32 v[230:231], v[230:231], v[118:119]
    v_pk_add_f32 v[232:233], v[232:233], v[120:121]
    v_pk_add_f32 v[234:235], v[234:235], v[122:123]
    v_pk_add_f32 v[236:237], v[236:237], v[124:125]
    v_pk_add_f32 v[238:239], v[238:239], v[126:127]
    v_cvt_pk_bf16_f32 v80, v224, v225
    v_cvt_pk_bf16_f32 v81, v226, v227
    v_cvt_pk_bf16_f32 v82, v228, v229
    v_cvt_pk_bf16_f32 v83, v230, v231
    v_cvt_pk_bf16_f32 v84, v232, v233
    v_cvt_pk_bf16_f32 v85, v234, v235
    v_cvt_pk_bf16_f32 v86, v236, v237
    v_cvt_pk_bf16_f32 v87, v238, v239
    s_mov_b32 exec_lo, 0xf0000000
    s_mov_b32 exec_hi, 0xf0000000
    v_mov_b32 v88, 0x3f803f80
    v_mov_b32 v89, 0x3f803f80
    v_mov_b32 v90, 0x3f803f80
    v_mov_b32 v91, 0x3f803f80
    v_mov_b32 v92, 0x3f803f80
    v_mov_b32 v93, 0x3f803f80
    v_mov_b32 v94, 0x3f803f80
    v_mov_b32 v95, 0x3f803f80
    v_mov_b32 v80, 0
    v_mov_b32 v81, 0
    v_mov_b32 v82, 0
    v_mov_b32 v83, 0
    v_mov_b32 v84, 0
    v_mov_b32 v85, 0
    v_mov_b32 v86, 0
    v_mov_b32 v87, 0
    s_mov_b64 exec, -1
    v_mfma_f32_32x32x16_bf16 v[144:159], v[80:83], v[88:91], v[144:159]
    v_mfma_f32_32x32x16_bf16 v[144:159], v[84:87], v[92:95], v[144:159]
    v_pk_mul_f32 v[112:113], v[160:161], s[30:31]
    v_pk_mul_f32 v[114:115], v[162:163], s[30:31]
    v_pk_mul_f32 v[116:117], v[164:165], s[30:31]
    v_pk_mul_f32 v[118:119], v[166:167], s[30:31]
    v_pk_mul_f32 v[120:121], v[168:169], s[30:31]
    v_pk_mul_f32 v[122:123], v[170:171], s[30:31]
    v_pk_mul_f32 v[124:125], v[172:173], s[30:31]
    v_pk_mul_f32 v[126:127], v[174:175], s[30:31]
    v_exp_f32 v112, v112 clamp
    v_exp_f32 v113, v113 clamp
    v_exp_f32 v114, v114 clamp
    v_exp_f32 v115, v115 clamp
    v_exp_f32 v116, v116 clamp
    v_exp_f32 v117, v117 clamp
    v_exp_f32 v118, v118 clamp
    v_exp_f32 v119, v119 clamp
    v_exp_f32 v120, v120 clamp
    v_exp_f32 v121, v121 clamp
    v_exp_f32 v122, v122 clamp
    v_exp_f32 v123, v123 clamp
    v_exp_f32 v124, v124 clamp
    v_exp_f32 v125, v125 clamp
    v_exp_f32 v126, v126 clamp
    v_exp_f32 v127, v127 clamp
    v_max_f32 v160, s37, v160
    v_max_f32 v161, s37, v161
    v_max_f32 v162, s37, v162
    v_max_f32 v163, s37, v163
    v_max_f32 v164, s37, v164
    v_max_f32 v165, s37, v165
    v_max_f32 v166, s37, v166
    v_max_f32 v167, s37, v167
    v_max_f32 v168, s37, v168
    v_max_f32 v169, s37, v169
    v_max_f32 v170, s37, v170
    v_max_f32 v171, s37, v171
    v_max_f32 v172, s37, v172
    v_max_f32 v173, s37, v173
    v_max_f32 v174, s37, v174
    v_max_f32 v175, s37, v175
    v_pk_add_f32 v[160:161], v[160:161], v[112:113]
    v_pk_add_f32 v[162:163], v[162:163], v[114:115]
    v_pk_add_f32 v[164:165], v[164:165], v[116:117]
    v_pk_add_f32 v[166:167], v[166:167], v[118:119]
    v_pk_add_f32 v[168:169], v[168:169], v[120:121]
    v_pk_add_f32 v[170:171], v[170:171], v[122:123]
    v_pk_add_f32 v[172:173], v[172:173], v[124:125]
    v_pk_add_f32 v[174:175], v[174:175], v[126:127]
    v_cvt_pk_bf16_f32 v96, v160, v161
    v_cvt_pk_bf16_f32 v97, v162, v163
    v_cvt_pk_bf16_f32 v98, v164, v165
    v_cvt_pk_bf16_f32 v99, v166, v167
    v_cvt_pk_bf16_f32 v100, v168, v169
    v_cvt_pk_bf16_f32 v101, v170, v171
    v_cvt_pk_bf16_f32 v102, v172, v173
    v_cvt_pk_bf16_f32 v103, v174, v175
    s_mov_b32 exec_lo, 0
    v_mov_b32 v102, 0
    v_mov_b32 v103, 0
    s_mov_b32 exec_lo, -1
    ds_write_b128 v5, v[96:99] offset:0
    ds_write_b128 v5, v[100:103] offset:1024
    ds_write_b128 v5, v[144:147] offset:4096
    ds_write_b128 v5, v[148:151] offset:5120
    ds_write_b128 v5, v[152:155] offset:6144
    ds_write_b128 v5, v[156:159] offset:7168
    v_pk_mul_f32 v[112:113], v[208:209], s[30:31]
    v_pk_mul_f32 v[114:115], v[210:211], s[30:31]
    v_pk_mul_f32 v[116:117], v[212:213], s[30:31]
    v_pk_mul_f32 v[118:119], v[214:215], s[30:31]
    v_pk_mul_f32 v[120:121], v[216:217], s[30:31]
    v_pk_mul_f32 v[122:123], v[218:219], s[30:31]
    v_pk_mul_f32 v[124:125], v[220:221], s[30:31]
    v_pk_mul_f32 v[126:127], v[222:223], s[30:31]
    v_exp_f32 v112, v112 clamp
    v_exp_f32 v113, v113 clamp
    v_exp_f32 v114, v114 clamp
    v_exp_f32 v115, v115 clamp
    v_exp_f32 v116, v116 clamp
    v_exp_f32 v117, v117 clamp
    v_exp_f32 v118, v118 clamp
    v_exp_f32 v119, v119 clamp
    v_exp_f32 v120, v120 clamp
    v_exp_f32 v121, v121 clamp
    v_exp_f32 v122, v122 clamp
    v_exp_f32 v123, v123 clamp
    v_exp_f32 v124, v124 clamp
    v_exp_f32 v125, v125 clamp
    v_exp_f32 v126, v126 clamp
    v_exp_f32 v127, v127 clamp
    v_max_f32 v208, s37, v208
    v_max_f32 v209, s37, v209
    v_max_f32 v210, s37, v210
    v_max_f32 v211, s37, v211
    v_max_f32 v212, s37, v212
    v_max_f32 v213, s37, v213
    v_max_f32 v214, s37, v214
    v_max_f32 v215, s37, v215
    v_max_f32 v216, s37, v216
    v_max_f32 v217, s37, v217
    v_max_f32 v218, s37, v218
    v_max_f32 v219, s37, v219
    v_max_f32 v220, s37, v220
    v_max_f32 v221, s37, v221
    v_max_f32 v222, s37, v222
    v_max_f32 v223, s37, v223
    v_pk_add_f32 v[208:209], v[208:209], v[112:113]
    v_pk_add_f32 v[210:211], v[210:211], v[114:115]
    v_pk_add_f32 v[212:213], v[212:213], v[116:117]
    v_pk_add_f32 v[214:215], v[214:215], v[118:119]
    v_pk_add_f32 v[216:217], v[216:217], v[120:121]
    v_pk_add_f32 v[218:219], v[218:219], v[122:123]
    v_pk_add_f32 v[220:221], v[220:221], v[124:125]
    v_pk_add_f32 v[222:223], v[222:223], v[126:127]
    v_cvt_pk_bf16_f32 v104, v208, v209
    v_cvt_pk_bf16_f32 v105, v210, v211
    v_cvt_pk_bf16_f32 v106, v212, v213
    v_cvt_pk_bf16_f32 v107, v214, v215
    v_cvt_pk_bf16_f32 v108, v216, v217
    v_cvt_pk_bf16_f32 v109, v218, v219
    v_cvt_pk_bf16_f32 v110, v220, v221
    v_cvt_pk_bf16_f32 v111, v222, v223
    s_mov_b32 exec_lo, 0
    v_mov_b32 v110, 0
    v_mov_b32 v111, 0
    s_mov_b32 exec_lo, -1
    ds_write_b128 v5, v[104:107] offset:2048
    ds_write_b128 v5, v[108:111] offset:3072
    s_waitcnt lgkmcnt(0)
L_P1DONE:
    s_barrier
    s_lshl_b32 s20, s38, 6
    s_lshl_b32 s21, s19, 4
    s_add_u32 s21, s20, s21
    s_lshl_b32 s21, s21, 12
    s_add_u32 s21, s21, 2097152
    s_mov_b32 s8, s12
    s_mov_b32 s9, s13
    s_add_u32 s10, s21, 0x10000
    s_mov_b32 s11, 0x20000
    s_lshl_b32 s22, s39, 2
    s_add_u32 s20, s20, s22
    s_add_u32 s22, s19, 1
    s_and_b32 s22, s22, 3
    s_add_u32 s22, s22, s20
    s_lshl_b32 s24, s22, 11
    s_add_u32 s22, s19, 2
    s_and_b32 s22, s22, 3
    s_add_u32 s22, s22, s20
    s_lshl_b32 s25, s22, 11
    s_add_u32 s22, s19, 3
    s_and_b32 s22, s22, 3
    s_add_u32 s22, s22, s20
    s_lshl_b32 s26, s22, 11
    s_add_u32 s22, s19, 4
    s_and_b32 s22, s22, 3
    s_add_u32 s22, s22, s20
    s_lshl_b32 s27, s22, 11
    s_mov_b32 s40, 57344
    s_mov_b32 s41, 10485760
    s_mov_b32 s42, 0
    s_mov_b32 s43, 13926400
    s_lshr_b32 s60, s2, 5
    s_and_b32 s28, s2, 7
    s_lshl_b32 s28, s28, 2
    s_bfe_u32 s29, s2, 0x20003
    s_add_u32 s28, s28, s29
    s_lshl_b32 s28, s28, 2
    s_and_b32 s29, s19, 3
    s_add_u32 s28, s28, s29
    s_lshr_b32 s29, s28, 1
    s_lshl_b32 s29, s29, 11
    s_add_u32 s43, s43, s29
    s_lshl_b32 s29, s28, 14
    s_add_u32 s41, s41, s29
    s_mul_i32 s28, s28, 28672
    s_add_u32 s42, s42, s28
    s_lshl_b32 s28, s60, 7
    s_add_u32 s42, s42, s28
    s_mov_b32 s50, 3670016
    s_mov_b32 s51, 0x20000
    v_lshrrev_b32 v38, 4, v2
    v_bfe_u32 v39, v2, 2, 2
    v_and_b32 v40, 3, v2
    v_lshrrev_b32 v41, 1, v38
    v_and_b32 v42, 1, v38
    v_lshlrev_b32 v43, 4, v41
    v_lshl_add_u32 v43, v42, 2, v43
    v_add_u32 v43, v43, v39
    v_add_u32 v44, 8, v43
    v_add_u32 v45, 24, v39
    v_cmp_eq_u32 vcc, 3, v38
    v_and_b32 v33, 15, v2
    v_lshlrev_b32 v32, 7, v33
    v_cndmask_b32 v44, v44, v45, vcc
    v_lshlrev_b32 v34, 4, v33
    v_lshl_add_u32 v34, v41, 8, v34
    v_lshl_add_u32 v34, v42, 14, v34
    v_mul_u32_u24 v33, 1792, v33
    v_lshl_add_u32 v33, v42, 5, v33
    v_lshl_add_u32 v33, v41, 4, v33
    v_lshrrev_b32 v41, 1, v40
    v_and_b32 v40, 1, v40
    v_lshlrev_b32 v40, 3, v40
    v_add_u32 v40, s40, v40
    v_and_b32 v45, 6, v43
    v_lshl_add_u32 v46, v43, 7, v40
    v_add_u32 v47, 0, v41
    v_xor_b32 v47, v47, v45
    v_lshl_add_u32 v16, v47, 4, v46
    v_xor_b32 v18, 64, v16
    v_add_u32 v47, 2, v41
    v_xor_b32 v47, v47, v45
    v_lshl_add_u32 v20, v47, 4, v46
    v_xor_b32 v22, 64, v20
    v_add_u32 v47, 4, v41
    v_xor_b32 v47, v47, v45
    v_lshl_add_u32 v24, v47, 4, v46
    v_xor_b32 v26, 64, v24
    v_add_u32 v47, 6, v41
    v_xor_b32 v47, v47, v45
    v_lshl_add_u32 v28, v47, 4, v46
    v_xor_b32 v30, 64, v28
    v_and_b32 v45, 6, v44
    v_lshl_add_u32 v46, v44, 7, v40
    v_add_u32 v47, 0, v41
    v_xor_b32 v47, v47, v45
    v_lshl_add_u32 v17, v47, 4, v46
    v_xor_b32 v19, 64, v17
    v_add_u32 v47, 2, v41
    v_xor_b32 v47, v47, v45
    v_lshl_add_u32 v21, v47, 4, v46
    v_xor_b32 v23, 64, v21
    v_add_u32 v47, 4, v41
    v_xor_b32 v47, v47, v45
    v_lshl_add_u32 v25, v47, 4, v46
    v_xor_b32 v27, 64, v25
    v_add_u32 v47, 6, v41
    v_xor_b32 v47, v47, v45
    v_lshl_add_u32 v29, v47, 4, v46
    v_xor_b32 v31, 64, v29
    s_mul_i32 s28, s38, 28
    s_lshr_b32 s29, s28, 5
    s_add_u32 s28, s28, 27
    s_lshr_b32 s28, s28, 5
    s_sub_u32 s28, s28, s29
    s_lshl_b32 s28, s28, 5
    s_lshl_b32 s22, s29, 12
    s_add_u32 s22, s22, 13631488
    v_and_b32 v8, 7, v2
    s_lshl_b32 s29, s19, 3
    v_add_u32 v8, s29, v8
    v_and_b32 v7, 1, v2
    s_lshl_b32 s29, s39, 1
    v_add_u32 v7, s29, v7
    v_cmp_gt_u32 vcc, 32, v2
    s_nop 1
    v_cndmask_b32 v8, v7, v8, vcc
    v_bfe_u32 v7, v2, 3, 1
    v_mad_u32_u24 v8, v7, s28, v8
    v_lshlrev_b32 v8, 7, v8
    s_waitcnt vmcnt(0)
    v_cmp_eq_u32 vcc, 16843009, v36
    s_nop 0
    s_cmp_eq_u64 vcc, -1
    s_cbranch_scc1 DBG11
    s_mov_b32 s62, 0x40000
POLL12:
    buffer_load_dword v3, v37, s[52:55], 0 offen sc1
    s_sub_u32 s62, s62, 1
    s_cbranch_scc1 POLL12_X
    s_waitcnt vmcnt(0)
    v_cmp_eq_u32 vcc, 16843009, v3
    s_nop 0
    s_cmp_eq_u64 vcc, -1
    s_cbranch_scc1 POLL12_X
    s_sleep 4
    s_branch POLL12
POLL12_X:
DBG11:
    s_cmp_eq_u32 s16, 1
    s_cbranch_scc1 L_NOF1
    s_cmp_eq_u32 s18, 7
    s_cbranch_scc1 L_NOF1
    s_mov_b64 exec, 1
    v_mov_b32 v3, 1
    v_mul_u32_u24 v4, 0, v2
    buffer_store_dword v3, v4, s[12:15], s36 offen sc1
    s_mov_b64 exec, -1
L_NOF1:
    s_mov_b32 s62, 0x40000
    s_mov_b32 exec_lo, 65535
    s_mov_b32 exec_hi, 771
POLL13:
    buffer_load_dword v3, v8, s[12:15], s22 offen sc1
    s_sub_u32 s62, s62, 1
    s_cbranch_scc1 POLL13_X
    s_waitcnt vmcnt(0)
    v_cmp_ne_u32 vcc, 1, v3
    s_nop 0
    s_and_b64 exec, exec, vcc
    s_cmp_eq_u64 exec, 0
    s_cbranch_scc0 POLL13
POLL13_X:
    s_mov_b64 exec, -1
    buffer_load_dwordx4 v[160:163], v1, s[12:15], s24 offen sc1
    buffer_load_dwordx4 v[164:167], v1, s[12:15], s24 offen offset:1024 sc1
    buffer_load_dwordx4 v[96:99], v1, s[8:11], s21 offen offset:0 sc1
    buffer_load_dwordx4 v[100:103], v1, s[8:11], s21 offen offset:1024 sc1
    buffer_load_dwordx4 v[168:171], v1, s[12:15], s25 offen sc1
    buffer_load_dwordx4 v[172:175], v1, s[12:15], s25 offen offset:1024 sc1
    buffer_load_dwordx4 v[104:107], v1, s[8:11], s21 offen offset:2048 sc1
    buffer_load_dwordx4 v[108:111], v1, s[8:11], s21 offen offset:3072 sc1
    s_add_u32 s21, s21, 4096
    buffer_load_dwordx4 v[176:179], v1, s[12:15], s26 offen sc1
    buffer_load_dwordx4 v[180:183], v1, s[12:15], s26 offen offset:1024 sc1
    buffer_load_dwordx4 v[184:187], v1, s[12:15], s27 offen sc1
    buffer_load_dwordx4 v[188:191], v1, s[12:15], s27 offen offset:1024 sc1
    buffer_load_dwordx4 v[112:115], v1, s[8:11], s21 offen offset:0 sc1
    buffer_load_dwordx4 v[116:119], v1, s[8:11], s21 offen offset:1024 sc1
    buffer_load_dwordx4 v[120:123], v1, s[8:11], s21 offen offset:2048 sc1
    buffer_load_dwordx4 v[124:127], v1, s[8:11], s21 offen offset:3072 sc1
    s_add_u32 s21, s21, 4096
    buffer_load_dwordx4 v[128:131], v1, s[8:11], s21 offen offset:0 sc1
    buffer_load_dwordx4 v[132:135], v1, s[8:11], s21 offen offset:1024 sc1
    buffer_load_dwordx4 v[136:139], v1, s[8:11], s21 offen offset:2048 sc1
    buffer_load_dwordx4 v[140:143], v1, s[8:11], s21 offen offset:3072 sc1
    s_add_u32 s21, s21, 4096
    s_mov_b32 s23, 3
    s_waitcnt vmcnt(16)
    s_mov_b64 exec, 1
    v_mov_b32 v4, 1
    ds_add_u32 v35, v4 offset:8
    s_mov_b64 exec, -1
    v_mfma_f32_32x32x16_bf16 v[64:79], v[96:99], v[160:163], 0
    v_mfma_f32_32x32x16_bf16 v[64:79], v[100:103], v[164:167], v[64:79]
    s_waitcnt vmcnt(14)
    v_mfma_f32_32x32x16_bf16 v[80:95], v[96:99], v[168:171], 0
    s_nop 9
    v_exp_f32 v64, v64
    v_exp_f32 v65, v65
    v_exp_f32 v66, v66
    v_exp_f32 v67, v67
    v_mfma_f32_32x32x16_bf16 v[80:95], v[100:103], v[172:175], v[80:95]
    v_exp_f32 v68, v68
    v_exp_f32 v69, v69
    v_exp_f32 v70, v70
    v_exp_f32 v71, v71
    v_cvt_pk_bf16_f32 v48, v64, v65
    v_cvt_pk_bf16_f32 v49, v66, v67
    v_exp_f32 v72, v72
    v_exp_f32 v73, v73
    v_exp_f32 v74, v74
    v_exp_f32 v75, v75
    v_cvt_pk_bf16_f32 v50, v68, v69
    v_cvt_pk_bf16_f32 v51, v70, v71
    v_exp_f32 v76, v76
    v_exp_f32 v77, v77
    v_exp_f32 v78, v78
    v_exp_f32 v79, v79
    v_cvt_pk_bf16_f32 v52, v72, v73
    v_cvt_pk_bf16_f32 v53, v74, v75
    v_cvt_pk_bf16_f32 v54, v76, v77
    v_cvt_pk_bf16_f32 v55, v78, v79
    s_waitcnt vmcnt(8)
    v_mfma_f32_32x32x16_bf16 v[64:79], v[96:99], v[176:179], 0
    v_exp_f32 v80, v80
    v_exp_f32 v81, v81
    v_exp_f32 v82, v82
    v_exp_f32 v83, v83
    buffer_load_dwordx4 v[144:147], v1, s[8:11], s21 offen offset:0 sc1
    v_mfma_f32_32x32x16_bf16 v[64:79], v[100:103], v[180:183], v[64:79]
    v_exp_f32 v84, v84
    v_exp_f32 v85, v85
    v_exp_f32 v86, v86
    v_exp_f32 v87, v87
    v_cvt_pk_bf16_f32 v56, v80, v81
    v_cvt_pk_bf16_f32 v57, v82, v83
    buffer_load_dwordx4 v[148:151], v1, s[8:11], s21 offen offset:1024 sc1
    v_mfma_f32_32x32x16_bf16 v[192:207], v[104:107], v[48:51], 0
    v_exp_f32 v88, v88
    v_exp_f32 v89, v89
    v_exp_f32 v90, v90
    v_exp_f32 v91, v91
    v_cvt_pk_bf16_f32 v58, v84, v85
    v_cvt_pk_bf16_f32 v59, v86, v87
    buffer_load_dwordx4 v[152:155], v1, s[8:11], s21 offen offset:2048 sc1
    v_mfma_f32_32x32x16_bf16 v[192:207], v[108:111], v[52:55], v[192:207]
    v_exp_f32 v92, v92
    v_exp_f32 v93, v93
    v_exp_f32 v94, v94
    v_exp_f32 v95, v95
    v_cvt_pk_bf16_f32 v60, v88, v89
    v_cvt_pk_bf16_f32 v61, v90, v91
    buffer_load_dwordx4 v[156:159], v1, s[8:11], s21 offen offset:3072 sc1
    s_add_u32 s21, s21, 4096
    v_cvt_pk_bf16_f32 v62, v92, v93
    v_cvt_pk_bf16_f32 v63, v94, v95
    v_mfma_f32_32x32x16_bf16 v[80:95], v[96:99], v[184:187], 0
    v_exp_f32 v64, v64
    v_exp_f32 v65, v65
    v_exp_f32 v66, v66
    v_exp_f32 v67, v67
    v_mfma_f32_32x32x16_bf16 v[80:95], v[100:103], v[188:191], v[80:95]
    v_exp_f32 v68, v68
    v_exp_f32 v69, v69
    v_exp_f32 v70, v70
    v_exp_f32 v71, v71
    v_cvt_pk_bf16_f32 v48, v64, v65
    v_cvt_pk_bf16_f32 v49, v66, v67
    v_mfma_f32_32x32x16_bf16 v[208:223], v[104:107], v[56:59], 0
    v_exp_f32 v72, v72
    v_exp_f32 v73, v73
    v_exp_f32 v74, v74
    v_exp_f32 v75, v75
    v_cvt_pk_bf16_f32 v50, v68, v69
    v_cvt_pk_bf16_f32 v51, v70, v71
    v_mfma_f32_32x32x16_bf16 v[208:223], v[108:111], v[60:63], v[208:223]
    v_exp_f32 v76, v76
    v_exp_f32 v77, v77
    v_exp_f32 v78, v78
    v_exp_f32 v79, v79
    v_cvt_pk_bf16_f32 v52, v72, v73
    v_cvt_pk_bf16_f32 v53, v74, v75
    v_cvt_pk_bf16_f32 v54, v76, v77
    v_cvt_pk_bf16_f32 v55, v78, v79
    s_waitcnt vmcnt(8)
    v_mfma_f32_32x32x16_bf16 v[64:79], v[112:115], v[160:163], 0
    v_exp_f32 v80, v80
    v_exp_f32 v81, v81
    v_exp_f32 v82, v82
    v_exp_f32 v83, v83
    v_mfma_f32_32x32x16_bf16 v[64:79], v[116:119], v[164:167], v[64:79]
    v_exp_f32 v84, v84
    v_exp_f32 v85, v85
    v_exp_f32 v86, v86
    v_exp_f32 v87, v87
    v_cvt_pk_bf16_f32 v56, v80, v81
    v_cvt_pk_bf16_f32 v57, v82, v83
    v_mfma_f32_32x32x16_bf16 v[224:239], v[104:107], v[48:51], 0
    v_exp_f32 v88, v88
    v_exp_f32 v89, v89
    v_exp_f32 v90, v90
    v_exp_f32 v91, v91
    v_cvt_pk_bf16_f32 v58, v84, v85
    v_cvt_pk_bf16_f32 v59, v86, v87
    v_mfma_f32_32x32x16_bf16 v[224:239], v[108:111], v[52:55], v[224:239]
    v_exp_f32 v92, v92
    v_exp_f32 v93, v93
    v_exp_f32 v94, v94
    v_exp_f32 v95, v95
    v_cvt_pk_bf16_f32 v60, v88, v89
    v_cvt_pk_bf16_f32 v61, v90, v91
    v_cvt_pk_bf16_f32 v62, v92, v93
    v_cvt_pk_bf16_f32 v63, v94, v95
    v_mfma_f32_32x32x16_bf16 v[80:95], v[112:115], v[168:171], 0
    v_exp_f32 v64, v64
    v_exp_f32 v65, v65
    v_exp_f32 v66, v66
    v_exp_f32 v67, v67
    v_mfma_f32_32x32x16_bf16 v[80:95], v[116:119], v[172:175], v[80:95]
    v_exp_f32 v68, v68
    v_exp_f32 v69, v69
    v_exp_f32 v70, v70
    v_exp_f32 v71, v71
    v_cvt_pk_bf16_f32 v48, v64, v65
    v_cvt_pk_bf16_f32 v49, v66, v67
    v_mfma_f32_32x32x16_bf16 v[240:255], v[104:107], v[56:59], 0
    v_exp_f32 v72, v72
    v_exp_f32 v73, v73
    v_exp_f32 v74, v74
    v_exp_f32 v75, v75
    v_cvt_pk_bf16_f32 v50, v68, v69
    v_cvt_pk_bf16_f32 v51, v70, v71
    v_mfma_f32_32x32x16_bf16 v[240:255], v[108:111], v[60:63], v[240:255]
    v_exp_f32 v76, v76
    v_exp_f32 v77, v77
    v_exp_f32 v78, v78
    v_exp_f32 v79, v79
    v_cvt_pk_bf16_f32 v52, v72, v73
    v_cvt_pk_bf16_f32 v53, v74, v75
    v_cvt_pk_bf16_f32 v54, v76, v77
    v_cvt_pk_bf16_f32 v55, v78, v79
    v_mfma_f32_32x32x16_bf16 v[64:79], v[112:115], v[176:179], 0
    v_exp_f32 v80, v80
    v_exp_f32 v81, v81
    v_exp_f32 v82, v82
    v_exp_f32 v83, v83
    buffer_load_dwordx4 v[96:99], v1, s[8:11], s21 offen offset:0 sc1
    v_mfma_f32_32x32x16_bf16 v[64:79], v[116:119], v[180:183], v[64:79]
    v_exp_f32 v84, v84
    v_exp_f32 v85, v85
    v_exp_f32 v86, v86
    v_exp_f32 v87, v87
    v_cvt_pk_bf16_f32 v56, v80, v81
    v_cvt_pk_bf16_f32 v57, v82, v83
    buffer_load_dwordx4 v[100:103], v1, s[8:11], s21 offen offset:1024 sc1
    v_mfma_f32_32x32x16_bf16 v[192:207], v[120:123], v[48:51], v[192:207]
    v_exp_f32 v88, v88
    v_exp_f32 v89, v89
    v_exp_f32 v90, v90
    v_exp_f32 v91, v91
    v_cvt_pk_bf16_f32 v58, v84, v85
    v_cvt_pk_bf16_f32 v59, v86, v87
    buffer_load_dwordx4 v[104:107], v1, s[8:11], s21 offen offset:2048 sc1
    v_mfma_f32_32x32x16_bf16 v[192:207], v[124:127], v[52:55], v[192:207]
    v_exp_f32 v92, v92
    v_exp_f32 v93, v93
    v_exp_f32 v94, v94
    v_exp_f32 v95, v95
    v_cvt_pk_bf16_f32 v60, v88, v89
    v_cvt_pk_bf16_f32 v61, v90, v91
    buffer_load_dwordx4 v[108:111], v1, s[8:11], s21 offen offset:3072 sc1
    s_add_u32 s21, s21, 4096
    v_cvt_pk_bf16_f32 v62, v92, v93
    v_cvt_pk_bf16_f32 v63, v94, v95
    v_mfma_f32_32x32x16_bf16 v[80:95], v[112:115], v[184:187], 0
    v_exp_f32 v64, v64
    v_exp_f32 v65, v65
    v_exp_f32 v66, v66
    v_exp_f32 v67, v67
    v_mfma_f32_32x32x16_bf16 v[80:95], v[116:119], v[188:191], v[80:95]
    v_exp_f32 v68, v68
    v_exp_f32 v69, v69
    v_exp_f32 v70, v70
    v_exp_f32 v71, v71
    v_cvt_pk_bf16_f32 v48, v64, v65
    v_cvt_pk_bf16_f32 v49, v66, v67
    v_mfma_f32_32x32x16_bf16 v[208:223], v[120:123], v[56:59], v[208:223]
    v_exp_f32 v72, v72
    v_exp_f32 v73, v73
    v_exp_f32 v74, v74
    v_exp_f32 v75, v75
    v_cvt_pk_bf16_f32 v50, v68, v69
    v_cvt_pk_bf16_f32 v51, v70, v71
    v_mfma_f32_32x32x16_bf16 v[208:223], v[124:127], v[60:63], v[208:223]
    v_exp_f32 v76, v76
    v_exp_f32 v77, v77
    v_exp_f32 v78, v78
    v_exp_f32 v79, v79
    v_cvt_pk_bf16_f32 v52, v72, v73
    v_cvt_pk_bf16_f32 v53, v74, v75
    v_cvt_pk_bf16_f32 v54, v76, v77
    v_cvt_pk_bf16_f32 v55, v78, v79
    s_waitcnt vmcnt(8)
    v_mfma_f32_32x32x16_bf16 v[64:79], v[128:131], v[160:163], 0
    v_exp_f32 v80, v80
    v_exp_f32 v81, v81
    v_exp_f32 v82, v82
    v_exp_f32 v83, v83
    v_mfma_f32_32x32x16_bf16 v[64:79], v[132:135], v[164:167], v[64:79]
    v_exp_f32 v84, v84
    v_exp_f32 v85, v85
    v_exp_f32 v86, v86
    v_exp_f32 v87, v87
    v_cvt_pk_bf16_f32 v56, v80, v81
    v_cvt_pk_bf16_f32 v57, v82, v83
    v_mfma_f32_32x32x16_bf16 v[224:239], v[120:123], v[48:51], v[224:239]
    v_exp_f32 v88, v88
    v_exp_f32 v89, v89
    v_exp_f32 v90, v90
    v_exp_f32 v91, v91
    v_cvt_pk_bf16_f32 v58, v84, v85
    v_cvt_pk_bf16_f32 v59, v86, v87
    v_mfma_f32_32x32x16_bf16 v[224:239], v[124:127], v[52:55], v[224:239]
    v_exp_f32 v92, v92
    v_exp_f32 v93, v93
    v_exp_f32 v94, v94
    v_exp_f32 v95, v95
    v_cvt_pk_bf16_f32 v60, v88, v89
    v_cvt_pk_bf16_f32 v61, v90, v91
    v_cvt_pk_bf16_f32 v62, v92, v93
    v_cvt_pk_bf16_f32 v63, v94, v95
    v_mfma_f32_32x32x16_bf16 v[80:95], v[128:131], v[168:171], 0
    v_exp_f32 v64, v64
    v_exp_f32 v65, v65
    v_exp_f32 v66, v66
    v_exp_f32 v67, v67
    v_mfma_f32_32x32x16_bf16 v[80:95], v[132:135], v[172:175], v[80:95]
    v_exp_f32 v68, v68
    v_exp_f32 v69, v69
    v_exp_f32 v70, v70
    v_exp_f32 v71, v71
    v_cvt_pk_bf16_f32 v48, v64, v65
    v_cvt_pk_bf16_f32 v49, v66, v67
    v_mfma_f32_32x32x16_bf16 v[240:255], v[120:123], v[56:59], v[240:255]
    v_exp_f32 v72, v72
    v_exp_f32 v73, v73
    v_exp_f32 v74, v74
    v_exp_f32 v75, v75
    v_cvt_pk_bf16_f32 v50, v68, v69
    v_cvt_pk_bf16_f32 v51, v70, v71
    v_mfma_f32_32x32x16_bf16 v[240:255], v[124:127], v[60:63], v[240:255]
    v_exp_f32 v76, v76
    v_exp_f32 v77, v77
    v_exp_f32 v78, v78
    v_exp_f32 v79, v79
    v_cvt_pk_bf16_f32 v52, v72, v73
    v_cvt_pk_bf16_f32 v53, v74, v75
    v_cvt_pk_bf16_f32 v54, v76, v77
    v_cvt_pk_bf16_f32 v55, v78, v79
    v_mfma_f32_32x32x16_bf16 v[64:79], v[128:131], v[176:179], 0
    v_exp_f32 v80, v80
    v_exp_f32 v81, v81
    v_exp_f32 v82, v82
    v_exp_f32 v83, v83
    buffer_load_dwordx4 v[112:115], v1, s[8:11], s21 offen offset:0 sc1
    v_mfma_f32_32x32x16_bf16 v[64:79], v[132:135], v[180:183], v[64:79]
    v_exp_f32 v84, v84
    v_exp_f32 v85, v85
    v_exp_f32 v86, v86
    v_exp_f32 v87, v87
    v_cvt_pk_bf16_f32 v56, v80, v81
    v_cvt_pk_bf16_f32 v57, v82, v83
    buffer_load_dwordx4 v[116:119], v1, s[8:11], s21 offen offset:1024 sc1
    v_mfma_f32_32x32x16_bf16 v[192:207], v[136:139], v[48:51], v[192:207]
    v_exp_f32 v88, v88
    v_exp_f32 v89, v89
    v_exp_f32 v90, v90
    v_exp_f32 v91, v91
    v_cvt_pk_bf16_f32 v58, v84, v85
    v_cvt_pk_bf16_f32 v59, v86, v87
    buffer_load_dwordx4 v[120:123], v1, s[8:11], s21 offen offset:2048 sc1
    v_mfma_f32_32x32x16_bf16 v[192:207], v[140:143], v[52:55], v[192:207]
    v_exp_f32 v92, v92
    v_exp_f32 v93, v93
    v_exp_f32 v94, v94
    v_exp_f32 v95, v95
    v_cvt_pk_bf16_f32 v60, v88, v89
    v_cvt_pk_bf16_f32 v61, v90, v91
    buffer_load_dwordx4 v[124:127], v1, s[8:11], s21 offen offset:3072 sc1
    s_add_u32 s21, s21, 4096
    v_cvt_pk_bf16_f32 v62, v92, v93
    v_cvt_pk_bf16_f32 v63, v94, v95
    v_mfma_f32_32x32x16_bf16 v[80:95], v[128:131], v[184:187], 0
    v_exp_f32 v64, v64
    v_exp_f32 v65, v65
    v_exp_f32 v66, v66
    v_exp_f32 v67, v67
    v_mfma_f32_32x32x16_bf16 v[80:95], v[132:135], v[188:191], v[80:95]
    v_exp_f32 v68, v68
    v_exp_f32 v69, v69
    v_exp_f32 v70, v70
    v_exp_f32 v71, v71
    v_cvt_pk_bf16_f32 v48, v64, v65
    v_cvt_pk_bf16_f32 v49, v66, v67
    v_mfma_f32_32x32x16_bf16 v[208:223], v[136:139], v[56:59], v[208:223]
    v_exp_f32 v72, v72
    v_exp_f32 v73, v73
    v_exp_f32 v74, v74
    v_exp_f32 v75, v75
    v_cvt_pk_bf16_f32 v50, v68, v69
    v_cvt_pk_bf16_f32 v51, v70, v71
    v_mfma_f32_32x32x16_bf16 v[208:223], v[140:143], v[60:63], v[208:223]
    v_exp_f32 v76, v76
    v_exp_f32 v77, v77
    v_exp_f32 v78, v78
    v_exp_f32 v79, v79
    v_cvt_pk_bf16_f32 v52, v72, v73
    v_cvt_pk_bf16_f32 v53, v74, v75
    v_cvt_pk_bf16_f32 v54, v76, v77
    v_cvt_pk_bf16_f32 v55, v78, v79
    s_waitcnt vmcnt(8)
    v_mfma_f32_32x32x16_bf16 v[64:79], v[144:147], v[160:163], 0
    v_exp_f32 v80, v80
    v_exp_f32 v81, v81
    v_exp_f32 v82, v82
    v_exp_f32 v83, v83
    v_mfma_f32_32x32x16_bf16 v[64:79], v[148:151], v[164:167], v[64:79]
    v_exp_f32 v84, v84
    v_exp_f32 v85, v85
    v_exp_f32 v86, v86
    v_exp_f32 v87, v87
    v_cvt_pk_bf16_f32 v56, v80, v81
    v_cvt_pk_bf16_f32 v57, v82, v83
    v_mfma_f32_32x32x16_bf16 v[224:239], v[136:139], v[48:51], v[224:239]
    v_exp_f32 v88, v88
    v_exp_f32 v89, v89
    v_exp_f32 v90, v90
    v_exp_f32 v91, v91
    v_cvt_pk_bf16_f32 v58, v84, v85
    v_cvt_pk_bf16_f32 v59, v86, v87
    v_mfma_f32_32x32x16_bf16 v[224:239], v[140:143], v[52:55], v[224:239]
    v_exp_f32 v92, v92
    v_exp_f32 v93, v93
    v_exp_f32 v94, v94
    v_exp_f32 v95, v95
    v_cvt_pk_bf16_f32 v60, v88, v89
    v_cvt_pk_bf16_f32 v61, v90, v91
    v_cvt_pk_bf16_f32 v62, v92, v93
    v_cvt_pk_bf16_f32 v63, v94, v95
    v_mfma_f32_32x32x16_bf16 v[80:95], v[144:147], v[168:171], 0
    v_exp_f32 v64, v64
    v_exp_f32 v65, v65
    v_exp_f32 v66, v66
    v_exp_f32 v67, v67
    v_mfma_f32_32x32x16_bf16 v[80:95], v[148:151], v[172:175], v[80:95]
    v_exp_f32 v68, v68
    v_exp_f32 v69, v69
    v_exp_f32 v70, v70
    v_exp_f32 v71, v71
    v_cvt_pk_bf16_f32 v48, v64, v65
    v_cvt_pk_bf16_f32 v49, v66, v67
    v_mfma_f32_32x32x16_bf16 v[240:255], v[136:139], v[56:59], v[240:255]
    v_exp_f32 v72, v72
    v_exp_f32 v73, v73
    v_exp_f32 v74, v74
    v_exp_f32 v75, v75
    v_cvt_pk_bf16_f32 v50, v68, v69
    v_cvt_pk_bf16_f32 v51, v70, v71
    v_mfma_f32_32x32x16_bf16 v[240:255], v[140:143], v[60:63], v[240:255]
    v_exp_f32 v76, v76
    v_exp_f32 v77, v77
    v_exp_f32 v78, v78
    v_exp_f32 v79, v79
    v_cvt_pk_bf16_f32 v52, v72, v73
    v_cvt_pk_bf16_f32 v53, v74, v75
    v_cvt_pk_bf16_f32 v54, v76, v77
    v_cvt_pk_bf16_f32 v55, v78, v79
    v_mfma_f32_32x32x16_bf16 v[64:79], v[144:147], v[176:179], 0
    v_exp_f32 v80, v80
    v_exp_f32 v81, v81
    v_exp_f32 v82, v82
    v_exp_f32 v83, v83
    buffer_load_dwordx4 v[128:131], v1, s[8:11], s21 offen offset:0 sc1
    v_mfma_f32_32x32x16_bf16 v[64:79], v[148:151], v[180:183], v[64:79]
    v_exp_f32 v84, v84
    v_exp_f32 v85, v85
    v_exp_f32 v86, v86
    v_exp_f32 v87, v87
    v_cvt_pk_bf16_f32 v56, v80, v81
    v_cvt_pk_bf16_f32 v57, v82, v83
    buffer_load_dwordx4 v[132:135], v1, s[8:11], s21 offen offset:1024 sc1
    v_mfma_f32_32x32x16_bf16 v[192:207], v[152:155], v[48:51], v[192:207]
    v_exp_f32 v88, v88
    v_exp_f32 v89, v89
    v_exp_f32 v90, v90
    v_exp_f32 v91, v91
    v_cvt_pk_bf16_f32 v58, v84, v85
    v_cvt_pk_bf16_f32 v59, v86, v87
    buffer_load_dwordx4 v[136:139], v1, s[8:11], s21 offen offset:2048 sc1
    v_mfma_f32_32x32x16_bf16 v[192:207], v[156:159], v[52:55], v[192:207]
    v_exp_f32 v92, v92
    v_exp_f32 v93, v93
    v_exp_f32 v94, v94
    v_exp_f32 v95, v95
    v_cvt_pk_bf16_f32 v60, v88, v89
    v_cvt_pk_bf16_f32 v61, v90, v91
    buffer_load_dwordx4 v[140:143], v1, s[8:11], s21 offen offset:3072 sc1
    s_add_u32 s21, s21, 4096
    v_cvt_pk_bf16_f32 v62, v92, v93
    v_cvt_pk_bf16_f32 v63, v94, v95
    v_mfma_f32_32x32x16_bf16 v[80:95], v[144:147], v[184:187], 0
    v_exp_f32 v64, v64
    v_exp_f32 v65, v65
    v_exp_f32 v66, v66
    v_exp_f32 v67, v67
    v_mfma_f32_32x32x16_bf16 v[80:95], v[148:151], v[188:191], v[80:95]
    v_exp_f32 v68, v68
    v_exp_f32 v69, v69
    v_exp_f32 v70, v70
    v_exp_f32 v71, v71
    v_cvt_pk_bf16_f32 v48, v64, v65
    v_cvt_pk_bf16_f32 v49, v66, v67
    v_mfma_f32_32x32x16_bf16 v[208:223], v[152:155], v[56:59], v[208:223]
    v_exp_f32 v72, v72
    v_exp_f32 v73, v73
    v_exp_f32 v74, v74
    v_exp_f32 v75, v75
    v_cvt_pk_bf16_f32 v50, v68, v69
    v_cvt_pk_bf16_f32 v51, v70, v71
    v_mfma_f32_32x32x16_bf16 v[208:223], v[156:159], v[60:63], v[208:223]
    v_exp_f32 v76, v76
    v_exp_f32 v77, v77
    v_exp_f32 v78, v78
    v_exp_f32 v79, v79
    v_cvt_pk_bf16_f32 v52, v72, v73
    v_cvt_pk_bf16_f32 v53, v74, v75
    v_cvt_pk_bf16_f32 v54, v76, v77
    v_cvt_pk_bf16_f32 v55, v78, v79
    s_waitcnt vmcnt(8)
    v_mfma_f32_32x32x16_bf16 v[64:79], v[96:99], v[160:163], 0
    v_exp_f32 v80, v80
    v_exp_f32 v81, v81
    v_exp_f32 v82, v82
    v_exp_f32 v83, v83
    v_mfma_f32_32x32x16_bf16 v[64:79], v[100:103], v[164:167], v[64:79]
    v_exp_f32 v84, v84
    v_exp_f32 v85, v85
    v_exp_f32 v86, v86
    v_exp_f32 v87, v87
    v_cvt_pk_bf16_f32 v56, v80, v81
    v_cvt_pk_bf16_f32 v57, v82, v83
    v_mfma_f32_32x32x16_bf16 v[224:239], v[152:155], v[48:51], v[224:239]
    v_exp_f32 v88, v88
    v_exp_f32 v89, v89
    v_exp_f32 v90, v90
    v_exp_f32 v91, v91
    v_cvt_pk_bf16_f32 v58, v84, v85
    v_cvt_pk_bf16_f32 v59, v86, v87
    v_mfma_f32_32x32x16_bf16 v[224:239], v[156:159], v[52:55], v[224:239]
    v_exp_f32 v92, v92
    v_exp_f32 v93, v93
    v_exp_f32 v94, v94
    v_exp_f32 v95, v95
    v_cvt_pk_bf16_f32 v60, v88, v89
    v_cvt_pk_bf16_f32 v61, v90, v91
    v_cvt_pk_bf16_f32 v62, v92, v93
    v_cvt_pk_bf16_f32 v63, v94, v95
    v_mfma_f32_32x32x16_bf16 v[80:95], v[96:99], v[168:171], 0
    v_exp_f32 v64, v64
    v_exp_f32 v65, v65
    v_exp_f32 v66, v66
    v_exp_f32 v67, v67
    v_mfma_f32_32x32x16_bf16 v[80:95], v[100:103], v[172:175], v[80:95]
    v_exp_f32 v68, v68
    v_exp_f32 v69, v69
    v_exp_f32 v70, v70
    v_exp_f32 v71, v71
    v_cvt_pk_bf16_f32 v48, v64, v65
    v_cvt_pk_bf16_f32 v49, v66, v67
    v_mfma_f32_32x32x16_bf16 v[240:255], v[152:155], v[56:59], v[240:255]
    v_exp_f32 v72, v72
    v_exp_f32 v73, v73
    v_exp_f32 v74, v74
    v_exp_f32 v75, v75
    v_cvt_pk_bf16_f32 v50, v68, v69
    v_cvt_pk_bf16_f32 v51, v70, v71
    v_mfma_f32_32x32x16_bf16 v[240:255], v[156:159], v[60:63], v[240:255]
    v_exp_f32 v76, v76
    v_exp_f32 v77, v77
    v_exp_f32 v78, v78
    v_exp_f32 v79, v79
    v_cvt_pk_bf16_f32 v52, v72, v73
    v_cvt_pk_bf16_f32 v53, v74, v75
    v_cvt_pk_bf16_f32 v54, v76, v77
    v_cvt_pk_bf16_f32 v55, v78, v79
.p2align 3
L_ATT:
    v_mfma_f32_32x32x16_bf16 v[64:79], v[96:99], v[176:179], 0
    v_exp_f32 v80, v80
    v_exp_f32 v81, v81
    v_exp_f32 v82, v82
    v_exp_f32 v83, v83
    buffer_load_dwordx4 v[144:147], v1, s[8:11], s21 offen offset:0 sc1
    v_mfma_f32_32x32x16_bf16 v[64:79], v[100:103], v[180:183], v[64:79]
    v_exp_f32 v84, v84
    v_exp_f32 v85, v85
    v_exp_f32 v86, v86
    v_exp_f32 v87, v87
    v_cvt_pk_bf16_f32 v56, v80, v81
    v_cvt_pk_bf16_f32 v57, v82, v83
    buffer_load_dwordx4 v[148:151], v1, s[8:11], s21 offen offset:1024 sc1
    v_mfma_f32_32x32x16_bf16 v[192:207], v[104:107], v[48:51], v[192:207]
    v_exp_f32 v88, v88
    v_exp_f32 v89, v89
    v_exp_f32 v90, v90
    v_exp_f32 v91, v91
    v_cvt_pk_bf16_f32 v58, v84, v85
    v_cvt_pk_bf16_f32 v59, v86, v87
    buffer_load_dwordx4 v[152:155], v1, s[8:11], s21 offen offset:2048 sc1
    v_mfma_f32_32x32x16_bf16 v[192:207], v[108:111], v[52:55], v[192:207]
    v_exp_f32 v92, v92
    v_exp_f32 v93, v93
    v_exp_f32 v94, v94
    v_exp_f32 v95, v95
    v_cvt_pk_bf16_f32 v60, v88, v89
    v_cvt_pk_bf16_f32 v61, v90, v91
    buffer_load_dwordx4 v[156:159], v1, s[8:11], s21 offen offset:3072 sc1
    s_add_u32 s21, s21, 4096
    v_cvt_pk_bf16_f32 v62, v92, v93
    v_cvt_pk_bf16_f32 v63, v94, v95
    v_mfma_f32_32x32x16_bf16 v[80:95], v[96:99], v[184:187], 0
    v_exp_f32 v64, v64
    v_exp_f32 v65, v65
    v_exp_f32 v66, v66
    v_exp_f32 v67, v67
    v_mfma_f32_32x32x16_bf16 v[80:95], v[100:103], v[188:191], v[80:95]
    v_exp_f32 v68, v68
    v_exp_f32 v69, v69
    v_exp_f32 v70, v70
    v_exp_f32 v71, v71
    v_cvt_pk_bf16_f32 v48, v64, v65
    v_cvt_pk_bf16_f32 v49, v66, v67
    v_mfma_f32_32x32x16_bf16 v[208:223], v[104:107], v[56:59], v[208:223]
    v_exp_f32 v72, v72
    v_exp_f32 v73, v73
    v_exp_f32 v74, v74
    v_exp_f32 v75, v75
    v_cvt_pk_bf16_f32 v50, v68, v69
    v_cvt_pk_bf16_f32 v51, v70, v71
    v_mfma_f32_32x32x16_bf16 v[208:223], v[108:111], v[60:63], v[208:223]
    v_exp_f32 v76, v76
    v_exp_f32 v77, v77
    v_exp_f32 v78, v78
    v_exp_f32 v79, v79
    v_cvt_pk_bf16_f32 v52, v72, v73
    v_cvt_pk_bf16_f32 v53, v74, v75
    v_cvt_pk_bf16_f32 v54, v76, v77
    v_cvt_pk_bf16_f32 v55, v78, v79
    s_waitcnt vmcnt(8)
    v_mfma_f32_32x32x16_bf16 v[64:79], v[112:115], v[160:163], 0
    v_exp_f32 v80, v80
    v_exp_f32 v81, v81
    v_exp_f32 v82, v82
    v_exp_f32 v83, v83
    v_mfma_f32_32x32x16_bf16 v[64:79], v[116:119], v[164:167], v[64:79]
    v_exp_f32 v84, v84
    v_exp_f32 v85, v85
    v_exp_f32 v86, v86
    v_exp_f32 v87, v87
    v_cvt_pk_bf16_f32 v56, v80, v81
    v_cvt_pk_bf16_f32 v57, v82, v83
    v_mfma_f32_32x32x16_bf16 v[224:239], v[104:107], v[48:51], v[224:239]
    v_exp_f32 v88, v88
    v_exp_f32 v89, v89
    v_exp_f32 v90, v90
    v_exp_f32 v91, v91
    v_cvt_pk_bf16_f32 v58, v84, v85
    v_cvt_pk_bf16_f32 v59, v86, v87
    v_mfma_f32_32x32x16_bf16 v[224:239], v[108:111], v[52:55], v[224:239]
    v_exp_f32 v92, v92
    v_exp_f32 v93, v93
    v_exp_f32 v94, v94
    v_exp_f32 v95, v95
    v_cvt_pk_bf16_f32 v60, v88, v89
    v_cvt_pk_bf16_f32 v61, v90, v91
    v_cvt_pk_bf16_f32 v62, v92, v93
    v_cvt_pk_bf16_f32 v63, v94, v95
    v_mfma_f32_32x32x16_bf16 v[80:95], v[112:115], v[168:171], 0
    v_exp_f32 v64, v64
    v_exp_f32 v65, v65
    v_exp_f32 v66, v66
    v_exp_f32 v67, v67
    v_mfma_f32_32x32x16_bf16 v[80:95], v[116:119], v[172:175], v[80:95]
    v_exp_f32 v68, v68
    v_exp_f32 v69, v69
    v_exp_f32 v70, v70
    v_exp_f32 v71, v71
    v_cvt_pk_bf16_f32 v48, v64, v65
    v_cvt_pk_bf16_f32 v49, v66, v67
    v_mfma_f32_32x32x16_bf16 v[240:255], v[104:107], v[56:59], v[240:255]
    v_exp_f32 v72, v72
    v_exp_f32 v73, v73
    v_exp_f32 v74, v74
    v_exp_f32 v75, v75
    v_cvt_pk_bf16_f32 v50, v68, v69
    v_cvt_pk_bf16_f32 v51, v70, v71
    v_mfma_f32_32x32x16_bf16 v[240:255], v[108:111], v[60:63], v[240:255]
    v_exp_f32 v76, v76
    v_exp_f32 v77, v77
    v_exp_f32 v78, v78
    v_exp_f32 v79, v79
    v_cvt_pk_bf16_f32 v52, v72, v73
    v_cvt_pk_bf16_f32 v53, v74, v75
    v_cvt_pk_bf16_f32 v54, v76, v77
    v_cvt_pk_bf16_f32 v55, v78, v79
    v_mfma_f32_32x32x16_bf16 v[64:79], v[112:115], v[176:179], 0
    v_exp_f32 v80, v80
    v_exp_f32 v81, v81
    v_exp_f32 v82, v82
    v_exp_f32 v83, v83
    buffer_load_dwordx4 v[96:99], v1, s[8:11], s21 offen offset:0 sc1
    v_mfma_f32_32x32x16_bf16 v[64:79], v[116:119], v[180:183], v[64:79]
    v_exp_f32 v84, v84
    v_exp_f32 v85, v85
    v_exp_f32 v86, v86
    v_exp_f32 v87, v87
    v_cvt_pk_bf16_f32 v56, v80, v81
    v_cvt_pk_bf16_f32 v57, v82, v83
    buffer_load_dwordx4 v[100:103], v1, s[8:11], s21 offen offset:1024 sc1
    v_mfma_f32_32x32x16_bf16 v[192:207], v[120:123], v[48:51], v[192:207]
    v_exp_f32 v88, v88
    v_exp_f32 v89, v89
    v_exp_f32 v90, v90
    v_exp_f32 v91, v91
    v_cvt_pk_bf16_f32 v58, v84, v85
    v_cvt_pk_bf16_f32 v59, v86, v87
    buffer_load_dwordx4 v[104:107], v1, s[8:11], s21 offen offset:2048 sc1
    v_mfma_f32_32x32x16_bf16 v[192:207], v[124:127], v[52:55], v[192:207]
    v_exp_f32 v92, v92
    v_exp_f32 v93, v93
    v_exp_f32 v94, v94
    v_exp_f32 v95, v95
    v_cvt_pk_bf16_f32 v60, v88, v89
    v_cvt_pk_bf16_f32 v61, v90, v91
    buffer_load_dwordx4 v[108:111], v1, s[8:11], s21 offen offset:3072 sc1
    s_add_u32 s21, s21, 4096
    v_cvt_pk_bf16_f32 v62, v92, v93
    v_cvt_pk_bf16_f32 v63, v94, v95
    v_mfma_f32_32x32x16_bf16 v[80:95], v[112:115], v[184:187], 0
    v_exp_f32 v64, v64
    v_exp_f32 v65, v65
    v_exp_f32 v66, v66
    v_exp_f32 v67, v67
    v_mfma_f32_32x32x16_bf16 v[80:95], v[116:119], v[188:191], v[80:95]
    v_exp_f32 v68, v68
    v_exp_f32 v69, v69
    v_exp_f32 v70, v70
    v_exp_f32 v71, v71
    v_cvt_pk_bf16_f32 v48, v64, v65
    v_cvt_pk_bf16_f32 v49, v66, v67
    v_mfma_f32_32x32x16_bf16 v[208:223], v[120:123], v[56:59], v[208:223]
    v_exp_f32 v72, v72
    v_exp_f32 v73, v73
    v_exp_f32 v74, v74
    v_exp_f32 v75, v75
    v_cvt_pk_bf16_f32 v50, v68, v69
    v_cvt_pk_bf16_f32 v51, v70, v71
    v_mfma_f32_32x32x16_bf16 v[208:223], v[124:127], v[60:63], v[208:223]
    v_exp_f32 v76, v76
    v_exp_f32 v77, v77
    v_exp_f32 v78, v78
    v_exp_f32 v79, v79
    v_cvt_pk_bf16_f32 v52, v72, v73
    v_cvt_pk_bf16_f32 v53, v74, v75
    v_cvt_pk_bf16_f32 v54, v76, v77
    v_cvt_pk_bf16_f32 v55, v78, v79
    s_waitcnt vmcnt(8)
    v_mfma_f32_32x32x16_bf16 v[64:79], v[128:131], v[160:163], 0
    v_exp_f32 v80, v80
    v_exp_f32 v81, v81
    v_exp_f32 v82, v82
    v_exp_f32 v83, v83
    v_mfma_f32_32x32x16_bf16 v[64:79], v[132:135], v[164:167], v[64:79]
    v_exp_f32 v84, v84
    v_exp_f32 v85, v85
    v_exp_f32 v86, v86
    v_exp_f32 v87, v87
    v_cvt_pk_bf16_f32 v56, v80, v81
    v_cvt_pk_bf16_f32 v57, v82, v83
    v_mfma_f32_32x32x16_bf16 v[224:239], v[120:123], v[48:51], v[224:239]
    v_exp_f32 v88, v88
    v_exp_f32 v89, v89
    v_exp_f32 v90, v90
    v_exp_f32 v91, v91
    v_cvt_pk_bf16_f32 v58, v84, v85
    v_cvt_pk_bf16_f32 v59, v86, v87
    v_mfma_f32_32x32x16_bf16 v[224:239], v[124:127], v[52:55], v[224:239]
    v_exp_f32 v92, v92
    v_exp_f32 v93, v93
    v_exp_f32 v94, v94
    v_exp_f32 v95, v95
    v_cvt_pk_bf16_f32 v60, v88, v89
    v_cvt_pk_bf16_f32 v61, v90, v91
    v_cvt_pk_bf16_f32 v62, v92, v93
    v_cvt_pk_bf16_f32 v63, v94, v95
    v_mfma_f32_32x32x16_bf16 v[80:95], v[128:131], v[168:171], 0
    v_exp_f32 v64, v64
    v_exp_f32 v65, v65
    v_exp_f32 v66, v66
    v_exp_f32 v67, v67
    v_mfma_f32_32x32x16_bf16 v[80:95], v[132:135], v[172:175], v[80:95]
    v_exp_f32 v68, v68
    v_exp_f32 v69, v69
    v_exp_f32 v70, v70
    v_exp_f32 v71, v71
    v_cvt_pk_bf16_f32 v48, v64, v65
    v_cvt_pk_bf16_f32 v49, v66, v67
    v_mfma_f32_32x32x16_bf16 v[240:255], v[120:123], v[56:59], v[240:255]
    v_exp_f32 v72, v72
    v_exp_f32 v73, v73
    v_exp_f32 v74, v74
    v_exp_f32 v75, v75
    v_cvt_pk_bf16_f32 v50, v68, v69
    v_cvt_pk_bf16_f32 v51, v70, v71
    v_mfma_f32_32x32x16_bf16 v[240:255], v[124:127], v[60:63], v[240:255]
    v_exp_f32 v76, v76
    v_exp_f32 v77, v77
    v_exp_f32 v78, v78
    v_exp_f32 v79, v79
    v_cvt_pk_bf16_f32 v52, v72, v73
    v_cvt_pk_bf16_f32 v53, v74, v75
    v_cvt_pk_bf16_f32 v54, v76, v77
    v_cvt_pk_bf16_f32 v55, v78, v79
    v_mfma_f32_32x32x16_bf16 v[64:79], v[128:131], v[176:179], 0
    v_exp_f32 v80, v80
    v_exp_f32 v81, v81
    v_exp_f32 v82, v82
    v_exp_f32 v83, v83
    buffer_load_dwordx4 v[112:115], v1, s[8:11], s21 offen offset:0 sc1
    v_mfma_f32_32x32x16_bf16 v[64:79], v[132:135], v[180:183], v[64:79]
    v_exp_f32 v84, v84
    v_exp_f32 v85, v85
    v_exp_f32 v86, v86
    v_exp_f32 v87, v87
    v_cvt_pk_bf16_f32 v56, v80, v81
    v_cvt_pk_bf16_f32 v57, v82, v83
    buffer_load_dwordx4 v[116:119], v1, s[8:11], s21 offen offset:1024 sc1
    v_mfma_f32_32x32x16_bf16 v[192:207], v[136:139], v[48:51], v[192:207]
    v_exp_f32 v88, v88
    v_exp_f32 v89, v89
    v_exp_f32 v90, v90
    v_exp_f32 v91, v91
    v_cvt_pk_bf16_f32 v58, v84, v85
    v_cvt_pk_bf16_f32 v59, v86, v87
    buffer_load_dwordx4 v[120:123], v1, s[8:11], s21 offen offset:2048 sc1
    v_mfma_f32_32x32x16_bf16 v[192:207], v[140:143], v[52:55], v[192:207]
    v_exp_f32 v92, v92
    v_exp_f32 v93, v93
    v_exp_f32 v94, v94
    v_exp_f32 v95, v95
    v_cvt_pk_bf16_f32 v60, v88, v89
    v_cvt_pk_bf16_f32 v61, v90, v91
    buffer_load_dwordx4 v[124:127], v1, s[8:11], s21 offen offset:3072 sc1
    s_add_u32 s21, s21, 4096
    v_cvt_pk_bf16_f32 v62, v92, v93
    v_cvt_pk_bf16_f32 v63, v94, v95
    v_mfma_f32_32x32x16_bf16 v[80:95], v[128:131], v[184:187], 0
    v_exp_f32 v64, v64
    v_exp_f32 v65, v65
    v_exp_f32 v66, v66
    v_exp_f32 v67, v67
    v_mfma_f32_32x32x16_bf16 v[80:95], v[132:135], v[188:191], v[80:95]
    v_exp_f32 v68, v68
    v_exp_f32 v69, v69
    v_exp_f32 v70, v70
    v_exp_f32 v71, v71
    v_cvt_pk_bf16_f32 v48, v64, v65
    v_cvt_pk_bf16_f32 v49, v66, v67
    v_mfma_f32_32x32x16_bf16 v[208:223], v[136:139], v[56:59], v[208:223]
    v_exp_f32 v72, v72
    v_exp_f32 v73, v73
    v_exp_f32 v74, v74
    v_exp_f32 v75, v75
    v_cvt_pk_bf16_f32 v50, v68, v69
    v_cvt_pk_bf16_f32 v51, v70, v71
    v_mfma_f32_32x32x16_bf16 v[208:223], v[140:143], v[60:63], v[208:223]
    v_exp_f32 v76, v76
    v_exp_f32 v77, v77
    v_exp_f32 v78, v78
    v_exp_f32 v79, v79
    v_cvt_pk_bf16_f32 v52, v72, v73
    v_cvt_pk_bf16_f32 v53, v74, v75
    v_cvt_pk_bf16_f32 v54, v76, v77
    v_cvt_pk_bf16_f32 v55, v78, v79
    s_waitcnt vmcnt(8)
    v_mfma_f32_32x32x16_bf16 v[64:79], v[144:147], v[160:163], 0
    v_exp_f32 v80, v80
    v_exp_f32 v81, v81
    v_exp_f32 v82, v82
    v_exp_f32 v83, v83
    v_mfma_f32_32x32x16_bf16 v[64:79], v[148:151], v[164:167], v[64:79]
    v_exp_f32 v84, v84
    v_exp_f32 v85, v85
    v_exp_f32 v86, v86
    v_exp_f32 v87, v87
    v_cvt_pk_bf16_f32 v56, v80, v81
    v_cvt_pk_bf16_f32 v57, v82, v83
    v_mfma_f32_32x32x16_bf16 v[224:239], v[136:139], v[48:51], v[224:239]
    v_exp_f32 v88, v88
    v_exp_f32 v89, v89
    v_exp_f32 v90, v90
    v_exp_f32 v91, v91
    v_cvt_pk_bf16_f32 v58, v84, v85
    v_cvt_pk_bf16_f32 v59, v86, v87
    v_mfma_f32_32x32x16_bf16 v[224:239], v[140:143], v[52:55], v[224:239]
    v_exp_f32 v92, v92
    v_exp_f32 v93, v93
    v_exp_f32 v94, v94
    v_exp_f32 v95, v95
    v_cvt_pk_bf16_f32 v60, v88, v89
    v_cvt_pk_bf16_f32 v61, v90, v91
    v_cvt_pk_bf16_f32 v62, v92, v93
    v_cvt_pk_bf16_f32 v63, v94, v95
    v_mfma_f32_32x32x16_bf16 v[80:95], v[144:147], v[168:171], 0
    v_exp_f32 v64, v64
    v_exp_f32 v65, v65
    v_exp_f32 v66, v66
    v_exp_f32 v67, v67
    v_mfma_f32_32x32x16_bf16 v[80:95], v[148:151], v[172:175], v[80:95]
    v_exp_f32 v68, v68
    v_exp_f32 v69, v69
    v_exp_f32 v70, v70
    v_exp_f32 v71, v71
    v_cvt_pk_bf16_f32 v48, v64, v65
    v_cvt_pk_bf16_f32 v49, v66, v67
    v_mfma_f32_32x32x16_bf16 v[240:255], v[136:139], v[56:59], v[240:255]
    v_exp_f32 v72, v72
    v_exp_f32 v73, v73
    v_exp_f32 v74, v74
    v_exp_f32 v75, v75
    v_cvt_pk_bf16_f32 v50, v68, v69
    v_cvt_pk_bf16_f32 v51, v70, v71
    v_mfma_f32_32x32x16_bf16 v[240:255], v[140:143], v[60:63], v[240:255]
    v_exp_f32 v76, v76
    v_exp_f32 v77, v77
    v_exp_f32 v78, v78
    v_exp_f32 v79, v79
    v_cvt_pk_bf16_f32 v52, v72, v73
    v_cvt_pk_bf16_f32 v53, v74, v75
    v_cvt_pk_bf16_f32 v54, v76, v77
    v_cvt_pk_bf16_f32 v55, v78, v79
    v_mfma_f32_32x32x16_bf16 v[64:79], v[144:147], v[176:179], 0
    v_exp_f32 v80, v80
    v_exp_f32 v81, v81
    v_exp_f32 v82, v82
    v_exp_f32 v83, v83
    buffer_load_dwordx4 v[128:131], v1, s[8:11], s21 offen offset:0 sc1
    v_mfma_f32_32x32x16_bf16 v[64:79], v[148:151], v[180:183], v[64:79]
    v_exp_f32 v84, v84
    v_exp_f32 v85, v85
    v_exp_f32 v86, v86
    v_exp_f32 v87, v87
    v_cvt_pk_bf16_f32 v56, v80, v81
    v_cvt_pk_bf16_f32 v57, v82, v83
    buffer_load_dwordx4 v[132:135], v1, s[8:11], s21 offen offset:1024 sc1
    v_mfma_f32_32x32x16_bf16 v[192:207], v[152:155], v[48:51], v[192:207]
    v_exp_f32 v88, v88
    v_exp_f32 v89, v89
    v_exp_f32 v90, v90
    v_exp_f32 v91, v91
    v_cvt_pk_bf16_f32 v58, v84, v85
    v_cvt_pk_bf16_f32 v59, v86, v87
    buffer_load_dwordx4 v[136:139], v1, s[8:11], s21 offen offset:2048 sc1
    v_mfma_f32_32x32x16_bf16 v[192:207], v[156:159], v[52:55], v[192:207]
    v_exp_f32 v92, v92
    v_exp_f32 v93, v93
    v_exp_f32 v94, v94
    v_exp_f32 v95, v95
    v_cvt_pk_bf16_f32 v60, v88, v89
    v_cvt_pk_bf16_f32 v61, v90, v91
    buffer_load_dwordx4 v[140:143], v1, s[8:11], s21 offen offset:3072 sc1
    s_add_u32 s21, s21, 4096
    v_cvt_pk_bf16_f32 v62, v92, v93
    v_cvt_pk_bf16_f32 v63, v94, v95
    v_mfma_f32_32x32x16_bf16 v[80:95], v[144:147], v[184:187], 0
    v_exp_f32 v64, v64
    v_exp_f32 v65, v65
    v_exp_f32 v66, v66
    v_exp_f32 v67, v67
    v_mfma_f32_32x32x16_bf16 v[80:95], v[148:151], v[188:191], v[80:95]
    v_exp_f32 v68, v68
    v_exp_f32 v69, v69
    v_exp_f32 v70, v70
    v_exp_f32 v71, v71
    v_cvt_pk_bf16_f32 v48, v64, v65
    v_cvt_pk_bf16_f32 v49, v66, v67
    v_mfma_f32_32x32x16_bf16 v[208:223], v[152:155], v[56:59], v[208:223]
    v_exp_f32 v72, v72
    v_exp_f32 v73, v73
    v_exp_f32 v74, v74
    v_exp_f32 v75, v75
    v_cvt_pk_bf16_f32 v50, v68, v69
    v_cvt_pk_bf16_f32 v51, v70, v71
    v_mfma_f32_32x32x16_bf16 v[208:223], v[156:159], v[60:63], v[208:223]
    v_exp_f32 v76, v76
    v_exp_f32 v77, v77
    v_exp_f32 v78, v78
    v_exp_f32 v79, v79
    v_cvt_pk_bf16_f32 v52, v72, v73
    v_cvt_pk_bf16_f32 v53, v74, v75
    v_cvt_pk_bf16_f32 v54, v76, v77
    v_cvt_pk_bf16_f32 v55, v78, v79
    s_waitcnt vmcnt(8)
    v_mfma_f32_32x32x16_bf16 v[64:79], v[96:99], v[160:163], 0
    v_exp_f32 v80, v80
    v_exp_f32 v81, v81
    v_exp_f32 v82, v82
    v_exp_f32 v83, v83
    v_mfma_f32_32x32x16_bf16 v[64:79], v[100:103], v[164:167], v[64:79]
    v_exp_f32 v84, v84
    v_exp_f32 v85, v85
    v_exp_f32 v86, v86
    v_exp_f32 v87, v87
    v_cvt_pk_bf16_f32 v56, v80, v81
    v_cvt_pk_bf16_f32 v57, v82, v83
    v_mfma_f32_32x32x16_bf16 v[224:239], v[152:155], v[48:51], v[224:239]
    v_exp_f32 v88, v88
    v_exp_f32 v89, v89
    v_exp_f32 v90, v90
    v_exp_f32 v91, v91
    v_cvt_pk_bf16_f32 v58, v84, v85
    v_cvt_pk_bf16_f32 v59, v86, v87
    v_mfma_f32_32x32x16_bf16 v[224:239], v[156:159], v[52:55], v[224:239]
    v_exp_f32 v92, v92
    v_exp_f32 v93, v93
    v_exp_f32 v94, v94
    v_exp_f32 v95, v95
    v_cvt_pk_bf16_f32 v60, v88, v89
    v_cvt_pk_bf16_f32 v61, v90, v91
    v_cvt_pk_bf16_f32 v62, v92, v93
    v_cvt_pk_bf16_f32 v63, v94, v95
    s_sub_u32 s23, s23, 1
    s_cmp_eq_u32 s23, 0
    s_cbranch_scc1 L_ATT_TAIL
    v_mfma_f32_32x32x16_bf16 v[80:95], v[96:99], v[168:171], 0
    v_exp_f32 v64, v64
    v_exp_f32 v65, v65
    v_exp_f32 v66, v66
    v_exp_f32 v67, v67
    v_mfma_f32_32x32x16_bf16 v[80:95], v[100:103], v[172:175], v[80:95]
    v_exp_f32 v68, v68
    v_exp_f32 v69, v69
    v_exp_f32 v70, v70
    v_exp_f32 v71, v71
    v_cvt_pk_bf16_f32 v48, v64, v65
    v_cvt_pk_bf16_f32 v49, v66, v67
    v_mfma_f32_32x32x16_bf16 v[240:255], v[152:155], v[56:59], v[240:255]
    v_exp_f32 v72, v72
    v_exp_f32 v73, v73
    v_exp_f32 v74, v74
    v_exp_f32 v75, v75
    v_cvt_pk_bf16_f32 v50, v68, v69
    v_cvt_pk_bf16_f32 v51, v70, v71
    v_mfma_f32_32x32x16_bf16 v[240:255], v[156:159], v[60:63], v[240:255]
    v_exp_f32 v76, v76
    v_exp_f32 v77, v77
    v_exp_f32 v78, v78
    v_exp_f32 v79, v79
    v_cvt_pk_bf16_f32 v52, v72, v73
    v_cvt_pk_bf16_f32 v53, v74, v75
    v_cvt_pk_bf16_f32 v54, v76, v77
    v_cvt_pk_bf16_f32 v55, v78, v79
    s_branch L_ATT
L_ATT_TAIL:
    ds_read_b32 v4, v35 offset:12
    v_mfma_f32_32x32x16_bf16 v[240:255], v[152:155], v[56:59], v[240:255]
    v_mfma_f32_32x32x16_bf16 v[240:255], v[156:159], v[60:63], v[240:255]
    s_cmp_eq_u32 s19, 0
    s_cselect_b32 s29, 0x7fffffff, -1
    s_waitcnt lgkmcnt(0)
    v_readfirstlane_b32 s28, v4
    s_nop 0
    s_cmp_ge_u32 s28, 1024
    s_cbranch_scc1 L_MERGE
    s_mov_b32 s63, 0x100000
LW14:
    ds_read_b32 v4, v35 offset:12
    s_sub_u32 s63, s63, 1
    s_cbranch_scc1 LW14_X
    s_waitcnt lgkmcnt(0)
    v_readfirstlane_b32 s28, v4
    s_nop 0
    s_cmp_ge_u32 s28, 1024
    s_cbranch_scc0 LW14
LW14_X:
    s_nop 7
L_MERGE:
    s_add_u32 s22, s19, 1
    s_and_b32 s22, s22, 3
    s_mul_i32 s22, s22, 12288
    s_add_u32 s22, s22, 114688
    v_add_u32 v3, s22, v1
    ds_write_b128 v3, v[192:195] offset:0
    ds_write_b128 v3, v[196:199] offset:1024
    ds_write_b128 v3, v[200:203] offset:2048
    ds_write_b128 v3, v[204:207] offset:3072
    s_add_u32 s22, s19, 2
    s_and_b32 s22, s22, 3
    s_mul_i32 s22, s22, 12288
    s_add_u32 s22, s22, 114688
    v_add_u32 v3, s22, v1
    ds_write_b128 v3, v[208:211] offset:4096
    ds_write_b128 v3, v[212:215] offset:5120
    ds_write_b128 v3, v[216:219] offset:6144
    ds_write_b128 v3, v[220:223] offset:7168
    s_add_u32 s22, s19, 3
    s_and_b32 s22, s22, 3
    s_mul_i32 s22, s22, 12288
    s_add_u32 s22, s22, 114688
    v_add_u32 v3, s22, v1
    ds_write_b128 v3, v[224:227] offset:8192
    ds_write_b128 v3, v[228:231] offset:9216
    ds_write_b128 v3, v[232:235] offset:10240
    s_mov_b32 exec_hi, s29
    ds_write_b128 v3, v[236:239] offset:11264
    s_mov_b32 exec_lo, 0
    s_mov_b32 exec_hi, 0x80000000
    ds_write_b32 v3, v236 offset:11264
    s_mov_b64 exec, -1
    s_mul_i32 s22, s19, 12288
    s_add_u32 s22, s22, 114688
    v_add_u32 v3, s22, v1
    s_waitcnt lgkmcnt(0)
    s_mov_b64 exec, 1
    v_mov_b32 v4, 1
    ds_add_u32 v35, v4 offset:12
    s_mov_b64 exec, -1
    s_mov_b32 s63, 0x100000
LW15:
    ds_read_b32 v4, v35 offset:12
    s_sub_u32 s63, s63, 1
    s_cbranch_scc1 LW15_X
    s_waitcnt lgkmcnt(0)
    v_readfirstlane_b32 s28, v4
    s_nop 0
    s_cmp_ge_u32 s28, 1028
    s_cbranch_scc0 LW15
LW15_X:
    ds_read_b128 v[192:195], v3 offset:0
    ds_read_b128 v[196:199], v3 offset:1024
    ds_read_b128 v[200:203], v3 offset:2048
    ds_read_b128 v[204:207], v3 offset:3072
    ds_read_b128 v[208:211], v3 offset:4096
    ds_read_b128 v[212:215], v3 offset:5120
    ds_read_b128 v[216:219], v3 offset:6144
    ds_read_b128 v[220:223], v3 offset:7168
    ds_read_b128 v[224:227], v3 offset:8192
    ds_read_b128 v[228:231], v3 offset:9216
    ds_read_b128 v[232:235], v3 offset:10240
    ds_read_b128 v[236:239], v3 offset:11264
    s_lshl_b32 s36, s39, 2
    s_add_u32 s36, s36, s19
    s_lshl_b32 s22, s36, 5
    s_add_u32 s22, s22, s38
    s_lshl_b32 s22, s22, 10
    s_add_u32 s22, s22, 10485760
    s_lshl_b32 s36, s36, 11
    s_lshl_b32 s37, s38, 7
    s_add_u32 s36, s36, s37
    s_add_u32 s36, s36, 13926400
    s_waitcnt lgkmcnt(8)
    v_pk_add_f32 v[240:241], v[240:241], v[192:193]
    v_pk_add_f32 v[242:243], v[242:243], v[194:195]
    v_pk_add_f32 v[244:245], v[244:245], v[196:197]
    v_pk_add_f32 v[246:247], v[246:247], v[198:199]
    v_pk_add_f32 v[248:249], v[248:249], v[200:201]
    v_pk_add_f32 v[250:251], v[250:251], v[202:203]
    v_pk_add_f32 v[252:253], v[252:253], v[204:205]
    v_pk_add_f32 v[254:255], v[254:255], v[206:207]
    s_waitcnt lgkmcnt(4)
    v_pk_add_f32 v[240:241], v[240:241], v[208:209]
    v_pk_add_f32 v[242:243], v[242:243], v[210:211]
    v_pk_add_f32 v[244:245], v[244:245], v[212:213]
    v_pk_add_f32 v[246:247], v[246:247], v[214:215]
    v_pk_add_f32 v[248:249], v[248:249], v[216:217]
    v_pk_add_f32 v[250:251], v[250:251], v[218:219]
    v_pk_add_f32 v[252:253], v[252:253], v[220:221]
    v_pk_add_f32 v[254:255], v[254:255], v[222:223]
    s_waitcnt lgkmcnt(0)
    v_pk_add_f32 v[240:241], v[240:241], v[224:225]
    v_pk_add_f32 v[242:243], v[242:243], v[226:227]
    v_pk_add_f32 v[244:245], v[244:245], v[228:229]
    v_pk_add_f32 v[246:247], v[246:247], v[230:231]
    v_pk_add_f32 v[248:249], v[248:249], v[232:233]
    v_pk_add_f32 v[250:251], v[250:251], v[234:235]
    v_pk_add_f32 v[252:253], v[252:253], v[236:237]
    v_pk_add_f32 v[254:255], v[254:255], v[238:239]
    v_mov_b32 v4, v252
    v_mov_b32 v5, v252
    v_add_f32 v6, |v240|, |v241|
    v_add_f32 v6, v6, |v242|
    v_add_f32 v6, v6, |v243|
    v_add_f32 v6, v6, |v244|
    v_add_f32 v6, v6, |v245|
    v_add_f32 v6, v6, |v246|
    v_add_f32 v6, v6, |v247|
    v_add_f32 v6, v6, |v248|
    v_add_f32 v6, v6, |v249|
    v_add_f32 v6, v6, |v250|
    v_add_f32 v6, v6, |v251|
    v_add_f32 v6, v6, |v252|
    v_add_f32 v6, v6, |v253|
    v_add_f32 v6, v6, |v254|
    v_add_f32 v6, v6, |v255|
    v_permlane32_swap_b32 v4, v5
    s_mov_b32 s28, 0x2b800000
    s_mov_b32 s30, 0x5f800000
    s_mov_b32 s31, 0x7f800000
    v_cmp_lt_f32 s[32:33], s28, v5
    v_cmp_gt_f32 s[34:35], s30, v5
    v_cmp_gt_f32 vcc, s31, v6
    s_and_b64 s[32:33], s[32:33], s[34:35]
    s_and_b64 s[32:33], s[32:33], vcc
    s_cmp_eq_u64 s[32:33], -1
    s_cbranch_scc0 L_FALLBACK
L_FINISH:
    v_rcp_f32 v5, v5
    s_nop 0
    v_mul_f32 v240, v240, v5
    v_mul_f32 v241, v241, v5
    v_mul_f32 v242, v242, v5
    v_mul_f32 v243, v243, v5
    v_mul_f32 v244, v244, v5
    v_mul_f32 v245, v245, v5
    v_mul_f32 v246, v246, v5
    v_mul_f32 v247, v247, v5
    v_mul_f32 v248, v248, v5
    v_mul_f32 v249, v249, v5
    v_mul_f32 v250, v250, v5
    v_mul_f32 v251, v251, v5
    v_mul_f32 v252, v252, v5
    v_mul_f32 v253, v253, v5
    v_mul_f32 v254, v254, v5
    v_mul_f32 v255, v255, v5
    v_cvt_pk_bf16_f32 v48, v240, v241
    v_cvt_pk_bf16_f32 v49, v242, v243
    v_cvt_pk_bf16_f32 v50, v244, v245
    v_cvt_pk_bf16_f32 v51, v246, v247
    v_cvt_pk_bf16_f32 v52, v248, v249
    v_cvt_pk_bf16_f32 v53, v250, v251
    v_cvt_pk_bf16_f32 v54, v252, v253
    v_cvt_pk_bf16_f32 v55, v254, v255
    s_mov_b32 exec_lo, 0
    v_mov_b32 v54, 0
    v_mov_b32 v55, 0
    s_mov_b32 exec_lo, -1
    buffer_store_dwordx4 v[48:51], v34, s[12:15], s22 offen sc1
    buffer_store_dwordx4 v[52:55], v34, s[12:15], s22 offen offset:512 sc1
    s_mov_b64 exec, 1
    v_mov_b32 v4, 1
    ds_add_u32 v35, v4 offset:8
    s_mov_b64 exec, -1
    s_waitcnt vmcnt(0)
    s_mov_b64 exec, 1
    v_mov_b32 v3, 1
    v_mov_b32 v4, 0
    buffer_store_dword v3, v4, s[12:15], s36 offen sc1
    s_mov_b64 exec, -1
    s_cmp_ge_u32 s2, 224
    s_cbranch_scc1 L_FIN
    ds_read_b64_tr_b16 v[160:161], v16 offset:0
    ds_read_b64_tr_b16 v[162:163], v17 offset:0
    ds_read_b64_tr_b16 v[164:165], v20 offset:0
    ds_read_b64_tr_b16 v[166:167], v21 offset:0
    ds_read_b64_tr_b16 v[168:169], v24 offset:0
    ds_read_b64_tr_b16 v[170:171], v25 offset:0
    ds_read_b64_tr_b16 v[172:173], v28 offset:0
    ds_read_b64_tr_b16 v[174:175], v29 offset:0
    ds_read_b64_tr_b16 v[176:177], v18 offset:3584
    ds_read_b64_tr_b16 v[178:179], v19 offset:3584
    ds_read_b64_tr_b16 v[180:181], v22 offset:3584
    ds_read_b64_tr_b16 v[182:183], v23 offset:3584
    ds_read_b64_tr_b16 v[184:185], v26 offset:3584
    ds_read_b64_tr_b16 v[186:187], v27 offset:3584
    ds_read_b64_tr_b16 v[188:189], v30 offset:3584
    ds_read_b64_tr_b16 v[190:191], v31 offset:3584
    ds_read_b64_tr_b16 v[192:193], v16 offset:7168
    ds_read_b64_tr_b16 v[194:195], v17 offset:7168
    ds_read_b64_tr_b16 v[196:197], v20 offset:7168
    ds_read_b64_tr_b16 v[198:199], v21 offset:7168
    ds_read_b64_tr_b16 v[200:201], v24 offset:7168
    ds_read_b64_tr_b16 v[202:203], v25 offset:7168
    ds_read_b64_tr_b16 v[204:205], v28 offset:7168
    ds_read_b64_tr_b16 v[206:207], v29 offset:7168
    ds_read_b64_tr_b16 v[208:209], v18 offset:10752
    ds_read_b64_tr_b16 v[210:211], v19 offset:10752
    ds_read_b64_tr_b16 v[212:213], v22 offset:10752
    ds_read_b64_tr_b16 v[214:215], v23 offset:10752
    ds_read_b64_tr_b16 v[216:217], v26 offset:10752
    ds_read_b64_tr_b16 v[218:219], v27 offset:10752
    ds_read_b64_tr_b16 v[220:221], v30 offset:10752
    ds_read_b64_tr_b16 v[222:223], v31 offset:10752
    ds_read_b64_tr_b16 v[224:225], v16 offset:14336
    ds_read_b64_tr_b16 v[226:227], v17 offset:14336
    ds_read_b64_tr_b16 v[228:229], v20 offset:14336
    ds_read_b64_tr_b16 v[230:231], v21 offset:14336
    ds_read_b64_tr_b16 v[232:233], v24 offset:14336
    ds_read_b64_tr_b16 v[234:235], v25 offset:14336
    ds_read_b64_tr_b16 v[236:237], v28 offset:14336
    ds_read_b64_tr_b16 v[238:239], v29 offset:14336
    ds_read_b64_tr_b16 v[240:241], v18 offset:17920
    ds_read_b64_tr_b16 v[242:243], v19 offset:17920
    ds_read_b64_tr_b16 v[244:245], v22 offset:17920
    ds_read_b64_tr_b16 v[246:247], v23 offset:17920
    ds_read_b64_tr_b16 v[248:249], v26 offset:17920
    ds_read_b64_tr_b16 v[250:251], v27 offset:17920
    ds_read_b64_tr_b16 v[252:253], v30 offset:17920
    ds_read_b64_tr_b16 v[254:255], v31 offset:17920
    ds_read_b64_tr_b16 v[128:129], v16 offset:21504
    ds_read_b64_tr_b16 v[130:131], v17 offset:21504
    ds_read_b64_tr_b16 v[132:133], v20 offset:21504
    ds_read_b64_tr_b16 v[134:135], v21 offset:21504
    ds_read_b64_tr_b16 v[136:137], v24 offset:21504
    ds_read_b64_tr_b16 v[138:139], v25 offset:21504
    ds_read_b64_tr_b16 v[140:141], v28 offset:21504
    ds_read_b64_tr_b16 v[142:143], v29 offset:21504
    ds_read_b64_tr_b16 v[48:49], v18 offset:25088
    ds_read_b64_tr_b16 v[50:51], v19 offset:25088
    ds_read_b64_tr_b16 v[52:53], v22 offset:25088
    ds_read_b64_tr_b16 v[54:55], v23 offset:25088
    ds_read_b64_tr_b16 v[56:57], v26 offset:25088
    ds_read_b64_tr_b16 v[58:59], v27 offset:25088
    ds_read_b64_tr_b16 v[60:61], v30 offset:25088
    ds_read_b64_tr_b16 v[62:63], v31 offset:25088
    s_mov_b32 s62, 0x40000
    s_mov_b32 exec_lo, 65535
    s_mov_b32 exec_hi, 0
POLL16:
    buffer_load_dword v3, v32, s[12:15], s43 offen sc1
    s_sub_u32 s62, s62, 1
    s_cbranch_scc1 POLL16_X
    s_waitcnt vmcnt(0)
    v_cmp_ne_u32 vcc, 1, v3
    s_nop 0
    s_and_b64 exec, exec, vcc
    s_cmp_eq_u64 exec, 0
    s_cbranch_scc0 POLL16
POLL16_X:
    s_mov_b64 exec, -1
    buffer_load_dwordx4 v[64:67], v1, s[12:15], s41 offen offset:0 sc1
    buffer_load_dwordx4 v[68:71], v1, s[12:15], s41 offen offset:1024 sc1
    buffer_load_dwordx4 v[72:75], v1, s[12:15], s41 offen offset:2048 sc1
    buffer_load_dwordx4 v[76:79], v1, s[12:15], s41 offen offset:3072 sc1
    s_add_u32 s41, s41, 4096
    buffer_load_dwordx4 v[80:83], v1, s[12:15], s41 offen offset:0 sc1
    buffer_load_dwordx4 v[84:87], v1, s[12:15], s41 offen offset:1024 sc1
    buffer_load_dwordx4 v[88:91], v1, s[12:15], s41 offen offset:2048 sc1
    buffer_load_dwordx4 v[92:95], v1, s[12:15], s41 offen offset:3072 sc1
    s_add_u32 s41, s41, 4096
    buffer_load_dwordx4 v[96:99], v1, s[12:15], s41 offen offset:0 sc1
    buffer_load_dwordx4 v[100:103], v1, s[12:15], s41 offen offset:1024 sc1
    buffer_load_dwordx4 v[104:107], v1, s[12:15], s41 offen offset:2048 sc1
    buffer_load_dwordx4 v[108:111], v1, s[12:15], s41 offen offset:3072 sc1
    s_add_u32 s41, s41, 4096
    buffer_load_dwordx4 v[112:115], v1, s[12:15], s41 offen offset:0 sc1
    buffer_load_dwordx4 v[116:119], v1, s[12:15], s41 offen offset:1024 sc1
    buffer_load_dwordx4 v[120:123], v1, s[12:15], s41 offen offset:2048 sc1
    buffer_load_dwordx4 v[124:127], v1, s[12:15], s41 offen offset:3072 sc1
    s_branch L_PROJ
L_FALLBACK:
    s_lshl_b32 s21, s38, 18
    s_add_u32 s21, s21, 2097152
    s_mov_b32 s23, 64
    v_mov_b32 v8, 0xff800000
    v_mov_b32 v240, 0
    v_mov_b32 v241, 0
    v_mov_b32 v242, 0
    v_mov_b32 v243, 0
    v_mov_b32 v244, 0
    v_mov_b32 v245, 0
    v_mov_b32 v246, 0
    v_mov_b32 v247, 0
    v_mov_b32 v248, 0
    v_mov_b32 v249, 0
    v_mov_b32 v250, 0
    v_mov_b32 v251, 0
    v_mov_b32 v252, 0
    v_mov_b32 v253, 0
    v_mov_b32 v254, 0
    v_mov_b32 v255, 0
L_FB_LOOP:
    buffer_load_dwordx4 v[96:99], v1, s[12:15], s21 offen offset:0 sc1
    buffer_load_dwordx4 v[100:103], v1, s[12:15], s21 offen offset:1024 sc1
    buffer_load_dwordx4 v[104:107], v1, s[12:15], s21 offen offset:2048 sc1
    buffer_load_dwordx4 v[108:111], v1, s[12:15], s21 offen offset:3072 sc1
    s_add_u32 s21, s21, 4096
    s_waitcnt vmcnt(0)
    v_mfma_f32_32x32x16_bf16 v[64:79], v[96:99], v[184:187], 0
    v_mfma_f32_32x32x16_bf16 v[64:79], v[100:103], v[188:191], v[64:79]
    s_nop 11
    v_max3_f32 v9, v64, v65, v8
    v_max3_f32 v9, v66, v67, v9
    v_max3_f32 v9, v68, v69, v9
    v_max3_f32 v9, v70, v71, v9
    v_max3_f32 v9, v72, v73, v9
    v_max3_f32 v9, v74, v75, v9
    v_max3_f32 v9, v76, v77, v9
    v_max3_f32 v9, v78, v79, v9
    v_mov_b32 v10, v9
    s_nop 1
    v_permlane32_swap_b32 v9, v10
    v_max_f32 v9, v9, v10
    v_sub_f32 v10, v8, v9
    v_exp_f32 v10, v10
    v_mov_b32 v8, v9
    v_sub_f32 v64, v64, v9
    v_sub_f32 v65, v65, v9
    v_sub_f32 v66, v66, v9
    v_sub_f32 v67, v67, v9
    v_sub_f32 v68, v68, v9
    v_sub_f32 v69, v69, v9
    v_sub_f32 v70, v70, v9
    v_sub_f32 v71, v71, v9
    v_sub_f32 v72, v72, v9
    v_sub_f32 v73, v73, v9
    v_sub_f32 v74, v74, v9
    v_sub_f32 v75, v75, v9
    v_sub_f32 v76, v76, v9
    v_sub_f32 v77, v77, v9
    v_sub_f32 v78, v78, v9
    v_sub_f32 v79, v79, v9
    v_exp_f32 v64, v64
    v_exp_f32 v65, v65
    v_exp_f32 v66, v66
    v_exp_f32 v67, v67
    v_exp_f32 v68, v68
    v_exp_f32 v69, v69
    v_exp_f32 v70, v70
    v_exp_f32 v71, v71
    v_exp_f32 v72, v72
    v_exp_f32 v73, v73
    v_exp_f32 v74, v74
    v_exp_f32 v75, v75
    v_exp_f32 v76, v76
    v_exp_f32 v77, v77
    v_exp_f32 v78, v78
    v_exp_f32 v79, v79
    v_mul_f32 v240, v240, v10
    v_mul_f32 v241, v241, v10
    v_mul_f32 v242, v242, v10
    v_mul_f32 v243, v243, v10
    v_mul_f32 v244, v244, v10
    v_mul_f32 v245, v245, v10
    v_mul_f32 v246, v246, v10
    v_mul_f32 v247, v247, v10
    v_mul_f32 v248, v248, v10
    v_mul_f32 v249, v249, v10
    v_mul_f32 v250, v250, v10
    v_mul_f32 v251, v251, v10
    v_mul_f32 v252, v252, v10
    v_mul_f32 v253, v253, v10
    v_mul_f32 v254, v254, v10
    v_mul_f32 v255, v255, v10
    v_cvt_pk_bf16_f32 v48, v64, v65
    v_cvt_pk_bf16_f32 v49, v66, v67
    v_cvt_pk_bf16_f32 v50, v68, v69
    v_cvt_pk_bf16_f32 v51, v70, v71
    v_cvt_pk_bf16_f32 v52, v72, v73
    v_cvt_pk_bf16_f32 v53, v74, v75
    v_cvt_pk_bf16_f32 v54, v76, v77
    v_cvt_pk_bf16_f32 v55, v78, v79
    v_mfma_f32_32x32x16_bf16 v[240:255], v[104:107], v[48:51], v[240:255]
    s_nop 0
    v_mfma_f32_32x32x16_bf16 v[240:255], v[108:111], v[52:55], v[240:255]
    s_sub_u32 s23, s23, 1
    s_cmp_lg_u32 s23, 0
    s_nop 15
    s_cbranch_scc1 L_FB_LOOP
    v_mov_b32 v4, v252
    v_mov_b32 v5, v252
    s_nop 1
    v_permlane32_swap_b32 v4, v5
    s_nop 1
    s_branch L_FINISH
L_IDLE:
    s_sub_u32 s31, s2, 112
    s_lshl_b32 s31, s31, 3
    s_add_u32 s31, s31, s19
    s_mul_i32 s23, s31, 3328
    s_add_u32 s23, s23, 13631488
    v_lshlrev_b32 v5, 7, v2
    v_mov_b32 v6, 0
    s_waitcnt lgkmcnt(0)
    s_mov_b32 s52, s50
    s_mov_b32 s53, s51
    s_mov_b64 exec, 0x3ffffff
    buffer_store_dword v6, v5, s[12:15], s23 offen sc1
    s_mov_b64 exec, 1
    v_mov_b32 v7, 1
    s_waitcnt vmcnt(0)
    buffer_store_byte v7, v6, s[52:55], s31 offen sc1
    s_mov_b64 exec, -1
    s_branch L_ROLE
L_NOLOAD:
    v_lshrrev_b32 v5, 4, v2
    v_lshlrev_b32 v5, 1, v5
    v_xor_b32 v6, v4, v5
    v_lshl_add_u32 v13, v6, 4, v7
    s_mov_b32 s46, 401408
    s_mov_b32 s47, 0x20000
    s_mov_b32 s58, 401408
    s_mov_b32 s59, 0x20000
    s_lshr_b32 s90, s2, 5
    s_lshl_b32 s90, s90, 7
    s_mul_i32 s91, s21, 100352
    s_add_u32 s90, s90, s91
    s_mul_i32 s91, s21, 14336
    v_lshlrev_b32 v1, 4, v2
    s_mov_b64 exec, 1
    v_mov_b32 v64, 0
    v_mov_b32 v65, 0
    ds_write_b64 v35, v[64:65]
    ds_write_b64 v35, v[64:65] offset:8
    s_mov_b64 exec, -1
    v_and_b32 v37, 31, v2
    v_lshlrev_b32 v37, 2, v37
    buffer_load_dword v36, v37, s[52:55], 0 offen sc1
    s_mov_b32 s40, 0
    s_mov_b32 s41, 8388608
    s_mov_b32 s42, 896
    s_mov_b32 s43, 13795328
    s_lshr_b32 s60, s2, 5
    s_and_b32 s28, s2, 7
    s_lshl_b32 s28, s28, 2
    s_bfe_u32 s29, s2, 0x20003
    s_add_u32 s28, s28, s29
    s_lshl_b32 s28, s28, 2
    s_and_b32 s29, s19, 3
    s_add_u32 s28, s28, s29
    s_lshr_b32 s29, s28, 1
    s_lshl_b32 s29, s29, 11
    s_add_u32 s43, s43, s29
    s_lshl_b32 s29, s28, 14
    s_add_u32 s41, s41, s29
    s_mul_i32 s28, s28, 28672
    s_add_u32 s42, s42, s28
    s_lshl_b32 s28, s60, 7
    s_add_u32 s42, s42, s28
    s_mov_b32 s50, 3670016
    s_mov_b32 s51, 0x20000
    v_lshrrev_b32 v38, 4, v2
    v_bfe_u32 v39, v2, 2, 2
    v_and_b32 v40, 3, v2
    v_lshrrev_b32 v41, 1, v38
    v_and_b32 v42, 1, v38
    v_lshlrev_b32 v43, 4, v41
    v_lshl_add_u32 v43, v42, 2, v43
    v_add_u32 v43, v43, v39
    v_add_u32 v44, 8, v43
    v_add_u32 v45, 24, v39
    v_cmp_eq_u32 vcc, 3, v38
    v_and_b32 v33, 15, v2
    v_lshlrev_b32 v32, 7, v33
    v_cndmask_b32 v44, v44, v45, vcc
    v_lshlrev_b32 v34, 4, v33
    v_lshl_add_u32 v34, v41, 8, v34
    v_lshl_add_u32 v34, v42, 14, v34
    v_mul_u32_u24 v33, 1792, v33
    v_lshl_add_u32 v33, v42, 5, v33
    v_lshl_add_u32 v33, v41, 4, v33
    v_lshrrev_b32 v41, 1, v40
    v_and_b32 v40, 1, v40
    v_lshlrev_b32 v40, 3, v40
    v_add_u32 v40, s40, v40
    v_and_b32 v45, 6, v43
    v_lshl_add_u32 v46, v43, 7, v40
    v_add_u32 v47, 0, v41
    v_xor_b32 v47, v47, v45
    v_lshl_add_u32 v16, v47, 4, v46
    v_xor_b32 v18, 64, v16
    v_add_u32 v47, 2, v41
    v_xor_b32 v47, v47, v45
    v_lshl_add_u32 v20, v47, 4, v46
    v_xor_b32 v22, 64, v20
    v_add_u32 v47, 4, v41
    v_xor_b32 v47, v47, v45
    v_lshl_add_u32 v24, v47, 4, v46
    v_xor_b32 v26, 64, v24
    v_add_u32 v47, 6, v41
    v_xor_b32 v47, v47, v45
    v_lshl_add_u32 v28, v47, 4, v46
    v_xor_b32 v30, 64, v28
    v_and_b32 v45, 6, v44
    v_lshl_add_u32 v46, v44, 7, v40
    v_add_u32 v47, 0, v41
    v_xor_b32 v47, v47, v45
    v_lshl_add_u32 v17, v47, 4, v46
    v_xor_b32 v19, 64, v17
    v_add_u32 v47, 2, v41
    v_xor_b32 v47, v47, v45
    v_lshl_add_u32 v21, v47, 4, v46
    v_xor_b32 v23, 64, v21
    v_add_u32 v47, 4, v41
    v_xor_b32 v47, v47, v45
    v_lshl_add_u32 v25, v47, 4, v46
    v_xor_b32 v27, 64, v25
    v_add_u32 v47, 6, v41
    v_xor_b32 v47, v47, v45
    v_lshl_add_u32 v29, v47, 4, v46
    v_xor_b32 v31, 64, v29
    s_lshr_b32 s22, s21, 1
    s_lshl_b32 s24, s18, 1
    s_add_u32 s24, s24, s22
    s_and_b32 s22, s21, 1
    s_waitcnt lgkmcnt(0)
    s_barrier
    s_cmp_eq_u32 s16, 1
    s_cbranch_scc1 L_HB
    s_cmp_lg_u32 s18, 7
    s_cbranch_scc1 L_HNI
    s_waitcnt vmcnt(0)
    v_mov_b32 v36, 16843009
L_HNI:
    s_waitcnt vmcnt(0)
    v_cmp_eq_u32 vcc, 16843009, v36
    s_nop 0
    s_cmp_eq_u64 vcc, -1
    s_cbranch_scc1 DBG17
    s_mov_b32 s62, 0x40000
POLL18:
    buffer_load_dword v3, v37, s[52:55], 0 offen sc1
    s_sub_u32 s62, s62, 1
    s_cbranch_scc1 POLL18_X
    s_waitcnt vmcnt(0)
    v_cmp_eq_u32 vcc, 16843009, v3
    s_nop 0
    s_cmp_eq_u64 vcc, -1
    s_cbranch_scc1 POLL18_X
    s_sleep 4
    s_branch POLL18
POLL18_X:
DBG17:
    s_cmp_lg_u32 s19, 4
    s_cbranch_scc1 L_HA
    s_and_b32 s24, s2, 15
    s_lshr_b32 s25, s2, 4
    s_lshl_b32 s23, s24, 12
    s_add_u32 s23, s23, 13697024
    s_lshl_b32 s26, s24, 16
    s_lshl_b32 s27, s25, 9
    s_add_u32 s26, s26, s27
    s_add_u32 s26, s26, 12582912
    v_and_b32 v8, 31, v2
    v_lshlrev_b32 v8, 7, v8
    v_lshlrev_b32 v9, 3, v2
    s_mov_b32 s62, 0x40000
POLL19:
    buffer_load_dword v3, v8, s[12:15], s23 offen sc1
    s_sub_u32 s62, s62, 1
    s_cbranch_scc1 POLL19_X
    s_waitcnt vmcnt(0)
    v_cmp_eq_u32 vcc, 1, v3
    s_nop 0
    s_cmp_eq_u64 vcc, -1
    s_cbranch_scc1 POLL19_X
    s_sleep 8
    s_branch POLL19
POLL19_X:
    buffer_load_dwordx2 v[64:65], v9, s[12:15], s26 offen sc1
    s_add_u32 s26, s26, 4096
    buffer_load_dwordx2 v[66:67], v9, s[12:15], s26 offen sc1
    s_add_u32 s26, s26, 4096
    buffer_load_dwordx2 v[68:69], v9, s[12:15], s26 offen sc1
    s_add_u32 s26, s26, 4096
    buffer_load_dwordx2 v[70:71], v9, s[12:15], s26 offen sc1
    s_add_u32 s26, s26, 4096
    buffer_load_dwordx2 v[72:73], v9, s[12:15], s26 offen sc1
    s_add_u32 s26, s26, 4096
    buffer_load_dwordx2 v[74:75], v9, s[12:15], s26 offen sc1
    s_add_u32 s26, s26, 4096
    buffer_load_dwordx2 v[76:77], v9, s[12:15], s26 offen sc1
    s_add_u32 s26, s26, 4096
    buffer_load_dwordx2 v[78:79], v9, s[12:15], s26 offen sc1
    s_add_u32 s26, s26, 4096
    buffer_load_dwordx2 v[80:81], v9, s[12:15], s26 offen sc1
    s_add_u32 s26, s26, 4096
    buffer_load_dwordx2 v[82:83], v9, s[12:15], s26 offen sc1
    s_add_u32 s26, s26, 4096
    buffer_load_dwordx2 v[84:85], v9, s[12:15], s26 offen sc1
    s_add_u32 s26, s26, 4096
    buffer_load_dwordx2 v[86:87], v9, s[12:15], s26 offen sc1
    s_add_u32 s26, s26, 4096
    buffer_load_dwordx2 v[88:89], v9, s[12:15], s26 offen sc1
    s_add_u32 s26, s26, 4096
    buffer_load_dwordx2 v[90:91], v9, s[12:15], s26 offen sc1
    s_add_u32 s26, s26, 4096
    buffer_load_dwordx2 v[92:93], v9, s[12:15], s26 offen sc1
    s_add_u32 s26, s26, 4096
    buffer_load_dwordx2 v[94:95], v9, s[12:15], s26 offen sc1
    s_add_u32 s26, s26, 4096
    s_and_b32 s26, s25, 1
    s_lshl_b32 s26, s26, 9
    s_lshr_b32 s27, s25, 2
    s_lshl_b32 s27, s27, 10
    s_add_u32 s26, s26, s27
    s_bfe_u32 s27, s25, 0x10001
    s_lshl_b32 s27, s27, 3
    s_add_u32 s26, s26, s27
    s_lshl_b32 s27, s24, 11
    s_add_u32 s26, s26, s27
    s_add_u32 s26, s26, 15204352
    v_lshrrev_b32 v9, 1, v2
    v_lshlrev_b32 v9, 4, v9
    v_and_b32 v8, 1, v2
    v_lshl_add_u32 v9, v8, 2, v9
    s_lshl_b32 s25, s25, 7
    s_lshl_b32 s23, s24, 10
    s_add_u32 s23, s23, s25
    s_add_u32 s23, s23, 13762560
    s_waitcnt vmcnt(0)
    v_pk_add_f32 v[64:65], v[64:65], v[80:81]
    v_pk_add_f32 v[66:67], v[66:67], v[82:83]
    v_pk_add_f32 v[68:69], v[68:69], v[84:85]
    v_pk_add_f32 v[70:71], v[70:71], v[86:87]
    v_pk_add_f32 v[72:73], v[72:73], v[88:89]
    v_pk_add_f32 v[74:75], v[74:75], v[90:91]
    v_pk_add_f32 v[76:77], v[76:77], v[92:93]
    v_pk_add_f32 v[78:79], v[78:79], v[94:95]
    v_pk_add_f32 v[64:65], v[64:65], v[72:73]
    v_pk_add_f32 v[66:67], v[66:67], v[74:75]
    v_pk_add_f32 v[68:69], v[68:69], v[76:77]
    v_pk_add_f32 v[70:71], v[70:71], v[78:79]
    v_pk_add_f32 v[64:65], v[64:65], v[68:69]
    v_pk_add_f32 v[66:67], v[66:67], v[70:71]
    v_pk_add_f32 v[64:65], v[64:65], v[66:67]
    v_cvt_pk_bf16_f32 v64, v64, v65
    buffer_store_dword v64, v9, s[12:15], s26 offen sc1
    s_waitcnt vmcnt(0)
    s_mov_b64 exec, 1
    v_mov_b32 v3, 1
    v_mov_b32 v4, 0
    buffer_store_dword v3, v4, s[12:15], s23 offen sc1
    s_mov_b64 exec, -1
L_HA:
    s_cmp_ge_u32 s2, 224
    s_cbranch_scc1 NOPAN20
    s_mov_b32 s63, 0x100000
LW21:
    ds_read_b32 v4, v35 offset:8
    s_sub_u32 s63, s63, 1
    s_cbranch_scc1 LW21_X
    s_waitcnt lgkmcnt(0)
    v_readfirstlane_b32 s28, v4
    s_nop 0
    s_cmp_ge_u32 s28, 4
    s_cbranch_scc1 LW21_X
    s_sleep 2
    s_branch LW21
LW21_X:
    s_add_u32 m0, s91, 0
    s_add_u32 s92, s90, 0
    buffer_load_dwordx4 v13, s[56:59], s92 offen lds
    s_add_u32 m0, s91, 1024
    s_add_u32 s92, s90, 7168
    buffer_load_dwordx4 v13, s[56:59], s92 offen lds
    s_add_u32 m0, s91, 2048
    s_add_u32 s92, s90, 14336
    buffer_load_dwordx4 v13, s[56:59], s92 offen lds
    s_add_u32 m0, s91, 3072
    s_add_u32 s92, s90, 21504
    buffer_load_dwordx4 v13, s[56:59], s92 offen lds
    s_waitcnt vmcnt(3)
    s_add_u32 m0, s91, 4096
    s_add_u32 s92, s90, 28672
    buffer_load_dwordx4 v13, s[56:59], s92 offen lds
    s_waitcnt vmcnt(3)
    s_add_u32 m0, s91, 5120
    s_add_u32 s92, s90, 35840
    buffer_load_dwordx4 v13, s[56:59], s92 offen lds
    s_waitcnt vmcnt(3)
    s_add_u32 m0, s91, 6144
    s_add_u32 s92, s90, 43008
    buffer_load_dwordx4 v13, s[56:59], s92 offen lds
    s_waitcnt vmcnt(3)
    s_add_u32 m0, s91, 7168
    s_add_u32 s92, s90, 50176
    buffer_load_dwordx4 v13, s[56:59], s92 offen lds
    s_waitcnt vmcnt(3)
    s_add_u32 m0, s91, 8192
    s_add_u32 s92, s90, 57344
    buffer_load_dwordx4 v13, s[56:59], s92 offen lds
    s_waitcnt vmcnt(3)
    s_add_u32 m0, s91, 9216
    s_add_u32 s92, s90, 64512
    buffer_load_dwordx4 v13, s[56:59], s92 offen lds
    s_waitcnt vmcnt(3)
    s_add_u32 m0, s91, 10240
    s_add_u32 s92, s90, 71680
    buffer_load_dwordx4 v13, s[56:59], s92 offen lds
    s_waitcnt vmcnt(3)
    s_add_u32 m0, s91, 11264
    s_add_u32 s92, s90, 78848
    buffer_load_dwordx4 v13, s[56:59], s92 offen lds
    s_waitcnt vmcnt(3)
    s_add_u32 m0, s91, 12288
    s_add_u32 s92, s90, 86016
    buffer_load_dwordx4 v13, s[56:59], s92 offen lds
    s_waitcnt vmcnt(3)
    s_add_u32 m0, s91, 13312
    s_add_u32 s92, s90, 93184
    buffer_load_dwordx4 v13, s[56:59], s92 offen lds
    s_waitcnt vmcnt(3)
    s_add_u32 m0, s91, 57344
    s_add_u32 s92, s90, 0
    buffer_load_dwordx4 v13, s[44:47], s92 offen lds
    s_waitcnt vmcnt(3)
    s_add_u32 m0, s91, 58368
    s_add_u32 s92, s90, 7168
    buffer_load_dwordx4 v13, s[44:47], s92 offen lds
    s_waitcnt vmcnt(3)
    s_add_u32 m0, s91, 59392
    s_add_u32 s92, s90, 14336
    buffer_load_dwordx4 v13, s[44:47], s92 offen lds
    s_waitcnt vmcnt(3)
    s_add_u32 m0, s91, 60416
    s_add_u32 s92, s90, 21504
    buffer_load_dwordx4 v13, s[44:47], s92 offen lds
    s_waitcnt vmcnt(3)
    s_add_u32 m0, s91, 61440
    s_add_u32 s92, s90, 28672
    buffer_load_dwordx4 v13, s[44:47], s92 offen lds
    s_waitcnt vmcnt(3)
    s_add_u32 m0, s91, 62464
    s_add_u32 s92, s90, 35840
    buffer_load_dwordx4 v13, s[44:47], s92 offen lds
    s_waitcnt vmcnt(3)
    s_add_u32 m0, s91, 63488
    s_add_u32 s92, s90, 43008
    buffer_load_dwordx4 v13, s[44:47], s92 offen lds
    s_waitcnt vmcnt(3)
    s_add_u32 m0, s91, 64512
    s_add_u32 s92, s90, 50176
    buffer_load_dwordx4 v13, s[44:47], s92 offen lds
    s_waitcnt vmcnt(3)
    s_add_u32 m0, s91, 65536
    s_add_u32 s92, s90, 57344
    buffer_load_dwordx4 v13, s[44:47], s92 offen lds
    s_waitcnt vmcnt(3)
    s_add_u32 m0, s91, 66560
    s_add_u32 s92, s90, 64512
    buffer_load_dwordx4 v13, s[44:47], s92 offen lds
    s_waitcnt vmcnt(3)
    s_add_u32 m0, s91, 67584
    s_add_u32 s92, s90, 71680
    buffer_load_dwordx4 v13, s[44:47], s92 offen lds
    s_waitcnt vmcnt(3)
    s_add_u32 m0, s91, 68608
    s_add_u32 s92, s90, 78848
    buffer_load_dwordx4 v13, s[44:47], s92 offen lds
    s_waitcnt vmcnt(3)
    s_add_u32 m0, s91, 69632
    s_add_u32 s92, s90, 86016
    buffer_load_dwordx4 v13, s[44:47], s92 offen lds
    s_waitcnt vmcnt(3)
    s_add_u32 m0, s91, 70656
    s_add_u32 s92, s90, 93184
    buffer_load_dwordx4 v13, s[44:47], s92 offen lds
NOPAN20:
    s_waitcnt vmcnt(0)
    s_mov_b64 exec, 1
    v_mov_b32 v4, 256
    ds_add_u32 v35, v4 offset:12
    s_mov_b64 exec, -1
    s_branch L_HPROJ
L_HB:
    s_lshl_b32 s25, s21, 13
    s_add_u32 s25, s25, 114688
    v_add_u32 v5, s25, v1
    s_and_b32 s25, s21, 2
    s_lshl_b32 s25, s25, 13
    s_lshl_b32 s26, s22, 11
    s_add_u32 s25, s25, s26
    s_add_u32 s25, s25, 118784
    v_add_u32 v6, s25, v1
    ds_read_b128 v[80:83], v6
    ds_read_b128 v[84:87], v6 offset:1024
    ds_read_b128 v[88:91], v6 offset:8192
    ds_read_b128 v[92:95], v6 offset:9216
    ds_read_b128 v[64:67], v5 offset:0
    ds_read_b128 v[68:71], v5 offset:1024
    ds_read_b128 v[72:75], v5 offset:2048
    ds_read_b128 v[76:79], v5 offset:3072
    s_lshl_b32 s25, s24, 4
    s_add_u32 s25, s25, s17
    s_lshl_b32 s25, s25, 12
    s_add_u32 s25, s25, s26
    s_add_u32 s25, s25, 12582912
    s_lshl_b32 s23, s24, 12
    s_lshl_b32 s26, s17, 1
    s_add_u32 s26, s26, s22
    s_lshl_b32 s27, s26, 7
    s_add_u32 s27, s27, s23
    s_add_u32 s27, s27, 13697024
    s_lshl_b32 s23, s24, 10
    s_add_u32 s23, s23, 13762560
    s_waitcnt lgkmcnt(4)
    v_pk_add_f32 v[80:81], v[80:81], v[88:89]
    v_pk_add_f32 v[82:83], v[82:83], v[90:91]
    v_pk_add_f32 v[84:85], v[84:85], v[92:93]
    v_pk_add_f32 v[86:87], v[86:87], v[94:95]
    buffer_store_dwordx4 v[80:83], v1, s[12:15], s25 offen sc1
    buffer_store_dwordx4 v[84:87], v1, s[12:15], s25 offen offset:1024 sc1
    s_lshl_b32 s25, s24, 11
    s_add_u32 s25, s25, 15204352
    s_lshl_b32 s36, s26, 6
    s_add_u32 s36, s36, s24
    s_lshl_b32 s36, s36, 10
    s_add_u32 s36, s36, 8388608
    s_add_u32 s37, s36, 32768
    s_lshl_b32 s26, s26, 12
    s_lshl_b32 s24, s24, 7
    s_add_u32 s26, s26, s24
    s_add_u32 s26, s26, 13795328
    v_and_b32 v8, 7, v2
    v_lshlrev_b32 v8, 7, v8
    s_waitcnt vmcnt(0) lgkmcnt(0)
    v_cmp_eq_u32 vcc, 16843009, v36
    s_nop 0
    s_cmp_eq_u64 vcc, -1
    s_cbranch_scc1 DBG22
    s_mov_b32 s62, 0x40000
POLL23:
    buffer_load_dword v3, v37, s[52:55], 0 offen sc1
    s_sub_u32 s62, s62, 1
    s_cbranch_scc1 POLL23_X
    s_waitcnt vmcnt(0)
    v_cmp_eq_u32 vcc, 16843009, v3
    s_nop 0
    s_cmp_eq_u64 vcc, -1
    s_cbranch_scc1 POLL23_X
    s_sleep 4
    s_branch POLL23
POLL23_X:
DBG22:
    s_mov_b64 exec, 1
    v_mov_b32 v3, 1
    v_mul_u32_u24 v4, 0, v2
    buffer_store_dword v3, v4, s[12:15], s27 offen sc1
    s_mov_b64 exec, -1
    s_cmp_ge_u32 s2, 224
    s_cbranch_scc1 NOPAN24
    s_mov_b32 s63, 0x100000
LW25:
    ds_read_b32 v4, v35 offset:8
    s_sub_u32 s63, s63, 1
    s_cbranch_scc1 LW25_X
    s_waitcnt lgkmcnt(0)
    v_readfirstlane_b32 s28, v4
    s_nop 0
    s_cmp_ge_u32 s28, 4
    s_cbranch_scc1 LW25_X
    s_sleep 2
    s_branch LW25
LW25_X:
    s_add_u32 m0, s91, 0
    s_add_u32 s92, s90, 0
    buffer_load_dwordx4 v13, s[56:59], s92 offen lds
    s_add_u32 m0, s91, 1024
    s_add_u32 s92, s90, 7168
    buffer_load_dwordx4 v13, s[56:59], s92 offen lds
    s_add_u32 m0, s91, 2048
    s_add_u32 s92, s90, 14336
    buffer_load_dwordx4 v13, s[56:59], s92 offen lds
    s_add_u32 m0, s91, 3072
    s_add_u32 s92, s90, 21504
    buffer_load_dwordx4 v13, s[56:59], s92 offen lds
    s_waitcnt vmcnt(3)
    s_add_u32 m0, s91, 4096
    s_add_u32 s92, s90, 28672
    buffer_load_dwordx4 v13, s[56:59], s92 offen lds
    s_waitcnt vmcnt(3)
    s_add_u32 m0, s91, 5120
    s_add_u32 s92, s90, 35840
    buffer_load_dwordx4 v13, s[56:59], s92 offen lds
    s_waitcnt vmcnt(3)
    s_add_u32 m0, s91, 6144
    s_add_u32 s92, s90, 43008
    buffer_load_dwordx4 v13, s[56:59], s92 offen lds
    s_waitcnt vmcnt(3)
    s_add_u32 m0, s91, 7168
    s_add_u32 s92, s90, 50176
    buffer_load_dwordx4 v13, s[56:59], s92 offen lds
    s_waitcnt vmcnt(3)
    s_add_u32 m0, s91, 8192
    s_add_u32 s92, s90, 57344
    buffer_load_dwordx4 v13, s[56:59], s92 offen lds
    s_waitcnt vmcnt(3)
    s_add_u32 m0, s91, 9216
    s_add_u32 s92, s90, 64512
    buffer_load_dwordx4 v13, s[56:59], s92 offen lds
    s_waitcnt vmcnt(3)
    s_add_u32 m0, s91, 10240
    s_add_u32 s92, s90, 71680
    buffer_load_dwordx4 v13, s[56:59], s92 offen lds
    s_waitcnt vmcnt(3)
    s_add_u32 m0, s91, 11264
    s_add_u32 s92, s90, 78848
    buffer_load_dwordx4 v13, s[56:59], s92 offen lds
    s_waitcnt vmcnt(3)
    s_add_u32 m0, s91, 12288
    s_add_u32 s92, s90, 86016
    buffer_load_dwordx4 v13, s[56:59], s92 offen lds
    s_waitcnt vmcnt(3)
    s_add_u32 m0, s91, 13312
    s_add_u32 s92, s90, 93184
    buffer_load_dwordx4 v13, s[56:59], s92 offen lds
    s_waitcnt vmcnt(3)
    s_add_u32 m0, s91, 57344
    s_add_u32 s92, s90, 0
    buffer_load_dwordx4 v13, s[44:47], s92 offen lds
    s_waitcnt vmcnt(3)
    s_add_u32 m0, s91, 58368
    s_add_u32 s92, s90, 7168
    buffer_load_dwordx4 v13, s[44:47], s92 offen lds
    s_waitcnt vmcnt(3)
    s_add_u32 m0, s91, 59392
    s_add_u32 s92, s90, 14336
    buffer_load_dwordx4 v13, s[44:47], s92 offen lds
    s_waitcnt vmcnt(3)
    s_add_u32 m0, s91, 60416
    s_add_u32 s92, s90, 21504
    buffer_load_dwordx4 v13, s[44:47], s92 offen lds
    s_waitcnt vmcnt(3)
    s_add_u32 m0, s91, 61440
    s_add_u32 s92, s90, 28672
    buffer_load_dwordx4 v13, s[44:47], s92 offen lds
    s_waitcnt vmcnt(3)
    s_add_u32 m0, s91, 62464
    s_add_u32 s92, s90, 35840
    buffer_load_dwordx4 v13, s[44:47], s92 offen lds
    s_waitcnt vmcnt(3)
    s_add_u32 m0, s91, 63488
    s_add_u32 s92, s90, 43008
    buffer_load_dwordx4 v13, s[44:47], s92 offen lds
    s_waitcnt vmcnt(3)
    s_add_u32 m0, s91, 64512
    s_add_u32 s92, s90, 50176
    buffer_load_dwordx4 v13, s[44:47], s92 offen lds
    s_waitcnt vmcnt(3)
    s_add_u32 m0, s91, 65536
    s_add_u32 s92, s90, 57344
    buffer_load_dwordx4 v13, s[44:47], s92 offen lds
    s_waitcnt vmcnt(3)
    s_add_u32 m0, s91, 66560
    s_add_u32 s92, s90, 64512
    buffer_load_dwordx4 v13, s[44:47], s92 offen lds
    s_waitcnt vmcnt(3)
    s_add_u32 m0, s91, 67584
    s_add_u32 s92, s90, 71680
    buffer_load_dwordx4 v13, s[44:47], s92 offen lds
    s_waitcnt vmcnt(3)
    s_add_u32 m0, s91, 68608
    s_add_u32 s92, s90, 78848
    buffer_load_dwordx4 v13, s[44:47], s92 offen lds
    s_waitcnt vmcnt(3)
    s_add_u32 m0, s91, 69632
    s_add_u32 s92, s90, 86016
    buffer_load_dwordx4 v13, s[44:47], s92 offen lds
    s_waitcnt vmcnt(3)
    s_add_u32 m0, s91, 70656
    s_add_u32 s92, s90, 93184
    buffer_load_dwordx4 v13, s[44:47], s92 offen lds
NOPAN24:
    s_waitcnt vmcnt(0)
    s_mov_b64 exec, 1
    v_mov_b32 v4, 256
    ds_add_u32 v35, v4 offset:12
    s_mov_b64 exec, -1
    s_mov_b32 s62, 0x40000
POLL26:
    buffer_load_dword v3, v8, s[12:15], s23 offen sc1
    s_sub_u32 s62, s62, 1
    s_cbranch_scc1 POLL26_X
    s_waitcnt vmcnt(0)
    v_cmp_eq_u32 vcc, 1, v3
    s_nop 0
    s_cmp_eq_u64 vcc, -1
    s_cbranch_scc1 POLL26_X
    s_sleep 8
    s_branch POLL26
POLL26_X:
    buffer_load_dwordx4 v[96:99], v1, s[12:15], s25 offen sc1
    buffer_load_dwordx4 v[100:103], v1, s[12:15], s25 offen offset:1024 sc1
    s_waitcnt vmcnt(0)
    v_mfma_f32_32x32x16_bf16 v[112:127], v[96:99], v[64:67], 0
    v_mfma_f32_32x32x16_bf16 v[112:127], v[100:103], v[68:71], v[112:127]
    v_mfma_f32_32x32x16_bf16 v[128:143], v[96:99], v[72:75], 0
    v_mfma_f32_32x32x16_bf16 v[128:143], v[100:103], v[76:79], v[128:143]
    s_nop 9
    v_mov_b32 v4, v124
    v_mov_b32 v5, v124
    s_nop 1
    v_permlane32_swap_b32 v4, v5
    v_add_f32 v5, 897988541, v5
    v_rcp_f32 v5, v5
    s_nop 0
    v_mul_f32 v112, v112, v5
    v_mul_f32 v113, v113, v5
    v_mul_f32 v114, v114, v5
    v_mul_f32 v115, v115, v5
    v_mul_f32 v116, v116, v5
    v_mul_f32 v117, v117, v5
    v_mul_f32 v118, v118, v5
    v_mul_f32 v119, v119, v5
    v_mul_f32 v120, v120, v5
    v_mul_f32 v121, v121, v5
    v_mul_f32 v122, v122, v5
    v_mul_f32 v123, v123, v5
    v_mul_f32 v124, v124, v5
    v_mul_f32 v125, v125, v5
    v_mul_f32 v126, v126, v5
    v_mul_f32 v127, v127, v5
    v_cvt_pk_bf16_f32 v48, v112, v113
    v_cvt_pk_bf16_f32 v49, v114, v115
    v_cvt_pk_bf16_f32 v50, v116, v117
    v_cvt_pk_bf16_f32 v51, v118, v119
    v_cvt_pk_bf16_f32 v52, v120, v121
    v_cvt_pk_bf16_f32 v53, v122, v123
    v_cvt_pk_bf16_f32 v54, v124, v125
    v_cvt_pk_bf16_f32 v55, v126, v127
    s_mov_b32 exec_lo, 0
    v_mov_b32 v54, 0
    v_mov_b32 v55, 0
    s_mov_b32 exec_lo, -1
    buffer_store_dwordx4 v[48:51], v34, s[12:15], s36 offen sc1
    buffer_store_dwordx4 v[52:55], v34, s[12:15], s36 offen offset:512 sc1
    v_mov_b32 v4, v140
    v_mov_b32 v5, v140
    s_nop 1
    v_permlane32_swap_b32 v4, v5
    v_add_f32 v5, 897988541, v5
    v_rcp_f32 v5, v5
    s_nop 0
    v_mul_f32 v128, v128, v5
    v_mul_f32 v129, v129, v5
    v_mul_f32 v130, v130, v5
    v_mul_f32 v131, v131, v5
    v_mul_f32 v132, v132, v5
    v_mul_f32 v133, v133, v5
    v_mul_f32 v134, v134, v5
    v_mul_f32 v135, v135, v5
    v_mul_f32 v136, v136, v5
    v_mul_f32 v137, v137, v5
    v_mul_f32 v138, v138, v5
    v_mul_f32 v139, v139, v5
    v_mul_f32 v140, v140, v5
    v_mul_f32 v141, v141, v5
    v_mul_f32 v142, v142, v5
    v_mul_f32 v143, v143, v5
    v_cvt_pk_bf16_f32 v56, v128, v129
    v_cvt_pk_bf16_f32 v57, v130, v131
    v_cvt_pk_bf16_f32 v58, v132, v133
    v_cvt_pk_bf16_f32 v59, v134, v135
    v_cvt_pk_bf16_f32 v60, v136, v137
    v_cvt_pk_bf16_f32 v61, v138, v139
    v_cvt_pk_bf16_f32 v62, v140, v141
    v_cvt_pk_bf16_f32 v63, v142, v143
    s_mov_b32 exec_lo, 0
    v_mov_b32 v62, 0
    v_mov_b32 v63, 0
    s_mov_b32 exec_lo, -1
    buffer_store_dwordx4 v[56:59], v34, s[12:15], s37 offen sc1
    buffer_store_dwordx4 v[60:63], v34, s[12:15], s37 offen offset:512 sc1
    s_waitcnt vmcnt(0)
    s_mov_b64 exec, 3
    v_mov_b32 v3, 1
    v_mul_u32_u24 v4, 2048, v2
    buffer_store_dword v3, v4, s[12:15], s26 offen sc1
    s_mov_b64 exec, -1
L_HPROJ:
    s_cmp_ge_u32 s2, 224
    s_cbranch_scc1 L_FIN
    s_mov_b32 s62, 0x40000
POLL27:
    buffer_load_dword v3, v32, s[12:15], s43 offen sc1
    s_sub_u32 s62, s62, 1
    s_cbranch_scc1 POLL27_X
    s_waitcnt vmcnt(0)
    v_cmp_eq_u32 vcc, 1, v3
    s_nop 0
    s_cmp_eq_u64 vcc, -1
    s_cbranch_scc1 POLL27_X
    s_sleep 8
    s_branch POLL27
POLL27_X:
    buffer_load_dwordx4 v[64:67], v1, s[12:15], s41 offen offset:0 sc1
    buffer_load_dwordx4 v[68:71], v1, s[12:15], s41 offen offset:1024 sc1
    buffer_load_dwordx4 v[72:75], v1, s[12:15], s41 offen offset:2048 sc1
    buffer_load_dwordx4 v[76:79], v1, s[12:15], s41 offen offset:3072 sc1
    s_add_u32 s41, s41, 4096
    buffer_load_dwordx4 v[80:83], v1, s[12:15], s41 offen offset:0 sc1
    buffer_load_dwordx4 v[84:87], v1, s[12:15], s41 offen offset:1024 sc1
    buffer_load_dwordx4 v[88:91], v1, s[12:15], s41 offen offset:2048 sc1
    buffer_load_dwordx4 v[92:95], v1, s[12:15], s41 offen offset:3072 sc1
    s_add_u32 s41, s41, 4096
    buffer_load_dwordx4 v[96:99], v1, s[12:15], s41 offen offset:0 sc1
    buffer_load_dwordx4 v[100:103], v1, s[12:15], s41 offen offset:1024 sc1
    buffer_load_dwordx4 v[104:107], v1, s[12:15], s41 offen offset:2048 sc1
    buffer_load_dwordx4 v[108:111], v1, s[12:15], s41 offen offset:3072 sc1
    s_add_u32 s41, s41, 4096
    buffer_load_dwordx4 v[112:115], v1, s[12:15], s41 offen offset:0 sc1
    buffer_load_dwordx4 v[116:119], v1, s[12:15], s41 offen offset:1024 sc1
    buffer_load_dwordx4 v[120:123], v1, s[12:15], s41 offen offset:2048 sc1
    buffer_load_dwordx4 v[124:127], v1, s[12:15], s41 offen offset:3072 sc1
    s_mov_b32 s63, 0x100000
LW28:
    ds_read_b32 v4, v35 offset:12
    s_sub_u32 s63, s63, 1
    s_cbranch_scc1 LW28_X
    s_waitcnt lgkmcnt(0)
    v_readfirstlane_b32 s28, v4
    s_nop 0
    s_cmp_ge_u32 s28, 1024
    s_cbranch_scc0 LW28
LW28_X:
    s_mov_b32 s63, 0x100000
LW29:
    ds_read_b32 v4, v35 offset:8
    s_sub_u32 s63, s63, 1
    s_cbranch_scc1 LW29_X
    s_waitcnt lgkmcnt(0)
    v_readfirstlane_b32 s28, v4
    s_nop 0
    s_cmp_ge_u32 s28, 8
    s_cbranch_scc1 LW29_X
    s_sleep 2
    s_branch LW29
LW29_X:
    ds_read_b64_tr_b16 v[160:161], v16 offset:0
    ds_read_b64_tr_b16 v[162:163], v17 offset:0
    ds_read_b64_tr_b16 v[164:165], v20 offset:0
    ds_read_b64_tr_b16 v[166:167], v21 offset:0
    ds_read_b64_tr_b16 v[168:169], v24 offset:0
    ds_read_b64_tr_b16 v[170:171], v25 offset:0
    ds_read_b64_tr_b16 v[172:173], v28 offset:0
    ds_read_b64_tr_b16 v[174:175], v29 offset:0
    ds_read_b64_tr_b16 v[176:177], v18 offset:3584
    ds_read_b64_tr_b16 v[178:179], v19 offset:3584
    ds_read_b64_tr_b16 v[180:181], v22 offset:3584
    ds_read_b64_tr_b16 v[182:183], v23 offset:3584
    ds_read_b64_tr_b16 v[184:185], v26 offset:3584
    ds_read_b64_tr_b16 v[186:187], v27 offset:3584
    ds_read_b64_tr_b16 v[188:189], v30 offset:3584
    ds_read_b64_tr_b16 v[190:191], v31 offset:3584
    ds_read_b64_tr_b16 v[192:193], v16 offset:7168
    ds_read_b64_tr_b16 v[194:195], v17 offset:7168
    ds_read_b64_tr_b16 v[196:197], v20 offset:7168
    ds_read_b64_tr_b16 v[198:199], v21 offset:7168
    ds_read_b64_tr_b16 v[200:201], v24 offset:7168
    ds_read_b64_tr_b16 v[202:203], v25 offset:7168
    ds_read_b64_tr_b16 v[204:205], v28 offset:7168
    ds_read_b64_tr_b16 v[206:207], v29 offset:7168
    ds_read_b64_tr_b16 v[208:209], v18 offset:10752
    ds_read_b64_tr_b16 v[210:211], v19 offset:10752
    ds_read_b64_tr_b16 v[212:213], v22 offset:10752
    ds_read_b64_tr_b16 v[214:215], v23 offset:10752
    ds_read_b64_tr_b16 v[216:217], v26 offset:10752
    ds_read_b64_tr_b16 v[218:219], v27 offset:10752
    ds_read_b64_tr_b16 v[220:221], v30 offset:10752
    ds_read_b64_tr_b16 v[222:223], v31 offset:10752
    ds_read_b64_tr_b16 v[224:225], v16 offset:14336
    ds_read_b64_tr_b16 v[226:227], v17 offset:14336
    ds_read_b64_tr_b16 v[228:229], v20 offset:14336
    ds_read_b64_tr_b16 v[230:231], v21 offset:14336
    ds_read_b64_tr_b16 v[232:233], v24 offset:14336
    ds_read_b64_tr_b16 v[234:235], v25 offset:14336
    ds_read_b64_tr_b16 v[236:237], v28 offset:14336
    ds_read_b64_tr_b16 v[238:239], v29 offset:14336
    ds_read_b64_tr_b16 v[240:241], v18 offset:17920
    ds_read_b64_tr_b16 v[242:243], v19 offset:17920
    ds_read_b64_tr_b16 v[244:245], v22 offset:17920
    ds_read_b64_tr_b16 v[246:247], v23 offset:17920
    ds_read_b64_tr_b16 v[248:249], v26 offset:17920
    ds_read_b64_tr_b16 v[250:251], v27 offset:17920
    ds_read_b64_tr_b16 v[252:253], v30 offset:17920
    ds_read_b64_tr_b16 v[254:255], v31 offset:17920
    ds_read_b64_tr_b16 v[128:129], v16 offset:21504
    ds_read_b64_tr_b16 v[130:131], v17 offset:21504
    ds_read_b64_tr_b16 v[132:133], v20 offset:21504
    ds_read_b64_tr_b16 v[134:135], v21 offset:21504
    ds_read_b64_tr_b16 v[136:137], v24 offset:21504
    ds_read_b64_tr_b16 v[138:139], v25 offset:21504
    ds_read_b64_tr_b16 v[140:141], v28 offset:21504
    ds_read_b64_tr_b16 v[142:143], v29 offset:21504
    ds_read_b64_tr_b16 v[48:49], v18 offset:25088
    ds_read_b64_tr_b16 v[50:51], v19 offset:25088
    ds_read_b64_tr_b16 v[52:53], v22 offset:25088
    ds_read_b64_tr_b16 v[54:55], v23 offset:25088
    ds_read_b64_tr_b16 v[56:57], v26 offset:25088
    ds_read_b64_tr_b16 v[58:59], v27 offset:25088
    ds_read_b64_tr_b16 v[60:61], v30 offset:25088
    ds_read_b64_tr_b16 v[62:63], v31 offset:25088
L_PROJ:
    s_waitcnt lgkmcnt(0) vmcnt(15)
    v_mfma_f32_16x16x32_bf16 v[144:147], v[160:163], v[64:67], 0
    ds_read_b64_tr_b16 v[160:161], v16 offset:28672
    ds_read_b64_tr_b16 v[162:163], v17 offset:28672
    v_mfma_f32_16x16x32_bf16 v[148:151], v[164:167], v[64:67], 0
    ds_read_b64_tr_b16 v[164:165], v20 offset:28672
    ds_read_b64_tr_b16 v[166:167], v21 offset:28672
    v_mfma_f32_16x16x32_bf16 v[152:155], v[168:171], v[64:67], 0
    ds_read_b64_tr_b16 v[168:169], v24 offset:28672
    ds_read_b64_tr_b16 v[170:171], v25 offset:28672
    v_mfma_f32_16x16x32_bf16 v[156:159], v[172:175], v[64:67], 0
    ds_read_b64_tr_b16 v[172:173], v28 offset:28672
    ds_read_b64_tr_b16 v[174:175], v29 offset:28672
    s_waitcnt vmcnt(14)
    v_mfma_f32_16x16x32_bf16 v[144:147], v[176:179], v[68:71], v[144:147]
    ds_read_b64_tr_b16 v[176:177], v18 offset:32256
    ds_read_b64_tr_b16 v[178:179], v19 offset:32256
    v_mfma_f32_16x16x32_bf16 v[148:151], v[180:183], v[68:71], v[148:151]
    ds_read_b64_tr_b16 v[180:181], v22 offset:32256
    ds_read_b64_tr_b16 v[182:183], v23 offset:32256
    v_mfma_f32_16x16x32_bf16 v[152:155], v[184:187], v[68:71], v[152:155]
    ds_read_b64_tr_b16 v[184:185], v26 offset:32256
    ds_read_b64_tr_b16 v[186:187], v27 offset:32256
    v_mfma_f32_16x16x32_bf16 v[156:159], v[188:191], v[68:71], v[156:159]
    ds_read_b64_tr_b16 v[188:189], v30 offset:32256
    ds_read_b64_tr_b16 v[190:191], v31 offset:32256
    s_waitcnt vmcnt(13)
    v_mfma_f32_16x16x32_bf16 v[144:147], v[192:195], v[72:75], v[144:147]
    v_mfma_f32_16x16x32_bf16 v[148:151], v[196:199], v[72:75], v[148:151]
    v_mfma_f32_16x16x32_bf16 v[152:155], v[200:203], v[72:75], v[152:155]
    v_mfma_f32_16x16x32_bf16 v[156:159], v[204:207], v[72:75], v[156:159]
    s_waitcnt vmcnt(12)
    v_mfma_f32_16x16x32_bf16 v[144:147], v[208:211], v[76:79], v[144:147]
    v_mfma_f32_16x16x32_bf16 v[148:151], v[212:215], v[76:79], v[148:151]
    v_mfma_f32_16x16x32_bf16 v[152:155], v[216:219], v[76:79], v[152:155]
    v_mfma_f32_16x16x32_bf16 v[156:159], v[220:223], v[76:79], v[156:159]
    s_waitcnt vmcnt(11)
    v_mfma_f32_16x16x32_bf16 v[144:147], v[224:227], v[80:83], v[144:147]
    v_mfma_f32_16x16x32_bf16 v[148:151], v[228:231], v[80:83], v[148:151]
    v_mfma_f32_16x16x32_bf16 v[152:155], v[232:235], v[80:83], v[152:155]
    v_mfma_f32_16x16x32_bf16 v[156:159], v[236:239], v[80:83], v[156:159]
    s_waitcnt vmcnt(10)
    v_mfma_f32_16x16x32_bf16 v[144:147], v[240:243], v[84:87], v[144:147]
    v_mfma_f32_16x16x32_bf16 v[148:151], v[244:247], v[84:87], v[148:151]
    v_mfma_f32_16x16x32_bf16 v[152:155], v[248:251], v[84:87], v[152:155]
    v_mfma_f32_16x16x32_bf16 v[156:159], v[252:255], v[84:87], v[156:159]
    s_waitcnt vmcnt(9)
    v_mfma_f32_16x16x32_bf16 v[144:147], v[128:131], v[88:91], v[144:147]
    v_mfma_f32_16x16x32_bf16 v[148:151], v[132:135], v[88:91], v[148:151]
    v_mfma_f32_16x16x32_bf16 v[152:155], v[136:139], v[88:91], v[152:155]
    v_mfma_f32_16x16x32_bf16 v[156:159], v[140:143], v[88:91], v[156:159]
    s_waitcnt vmcnt(8)
    v_mfma_f32_16x16x32_bf16 v[144:147], v[48:51], v[92:95], v[144:147]
    v_mfma_f32_16x16x32_bf16 v[148:151], v[52:55], v[92:95], v[148:151]
    v_mfma_f32_16x16x32_bf16 v[152:155], v[56:59], v[92:95], v[152:155]
    v_mfma_f32_16x16x32_bf16 v[156:159], v[60:63], v[92:95], v[156:159]
    s_waitcnt lgkmcnt(14) vmcnt(7)
    v_mfma_f32_16x16x32_bf16 v[144:147], v[160:163], v[96:99], v[144:147]
    ds_read_b64_tr_b16 v[160:161], v16 offset:35840
    ds_read_b64_tr_b16 v[162:163], v17 offset:35840
    s_waitcnt lgkmcnt(14)
    v_mfma_f32_16x16x32_bf16 v[148:151], v[164:167], v[96:99], v[148:151]
    ds_read_b64_tr_b16 v[164:165], v20 offset:35840
    ds_read_b64_tr_b16 v[166:167], v21 offset:35840
    s_waitcnt lgkmcnt(14)
    v_mfma_f32_16x16x32_bf16 v[152:155], v[168:171], v[96:99], v[152:155]
    ds_read_b64_tr_b16 v[168:169], v24 offset:35840
    ds_read_b64_tr_b16 v[170:171], v25 offset:35840
    s_waitcnt lgkmcnt(14)
    v_mfma_f32_16x16x32_bf16 v[156:159], v[172:175], v[96:99], v[156:159]
    ds_read_b64_tr_b16 v[172:173], v28 offset:35840
    ds_read_b64_tr_b16 v[174:175], v29 offset:35840
    s_waitcnt lgkmcnt(14) vmcnt(6)
    v_mfma_f32_16x16x32_bf16 v[144:147], v[176:179], v[100:103], v[144:147]
    ds_read_b64_tr_b16 v[176:177], v18 offset:39424
    ds_read_b64_tr_b16 v[178:179], v19 offset:39424
    s_waitcnt lgkmcnt(14)
    v_mfma_f32_16x16x32_bf16 v[148:151], v[180:183], v[100:103], v[148:151]
    ds_read_b64_tr_b16 v[180:181], v22 offset:39424
    ds_read_b64_tr_b16 v[182:183], v23 offset:39424
    s_waitcnt lgkmcnt(14)
    v_mfma_f32_16x16x32_bf16 v[152:155], v[184:187], v[100:103], v[152:155]
    ds_read_b64_tr_b16 v[184:185], v26 offset:39424
    ds_read_b64_tr_b16 v[186:187], v27 offset:39424
    s_waitcnt lgkmcnt(14)
    v_mfma_f32_16x16x32_bf16 v[156:159], v[188:191], v[100:103], v[156:159]
    ds_read_b64_tr_b16 v[188:189], v30 offset:39424
    ds_read_b64_tr_b16 v[190:191], v31 offset:39424
    s_waitcnt lgkmcnt(14) vmcnt(5)
    v_mfma_f32_16x16x32_bf16 v[144:147], v[160:163], v[104:107], v[144:147]
    ds_read_b64_tr_b16 v[160:161], v16 offset:43008
    ds_read_b64_tr_b16 v[162:163], v17 offset:43008
    s_waitcnt lgkmcnt(14)
    v_mfma_f32_16x16x32_bf16 v[148:151], v[164:167], v[104:107], v[148:151]
    ds_read_b64_tr_b16 v[164:165], v20 offset:43008
    ds_read_b64_tr_b16 v[166:167], v21 offset:43008
    s_waitcnt lgkmcnt(14)
    v_mfma_f32_16x16x32_bf16 v[152:155], v[168:171], v[104:107], v[152:155]
    ds_read_b64_tr_b16 v[168:169], v24 offset:43008
    ds_read_b64_tr_b16 v[170:171], v25 offset:43008
    s_waitcnt lgkmcnt(14)
    v_mfma_f32_16x16x32_bf16 v[156:159], v[172:175], v[104:107], v[156:159]
    ds_read_b64_tr_b16 v[172:173], v28 offset:43008
    ds_read_b64_tr_b16 v[174:175], v29 offset:43008
    s_waitcnt lgkmcnt(14) vmcnt(4)
    v_mfma_f32_16x16x32_bf16 v[144:147], v[176:179], v[108:111], v[144:147]
    ds_read_b64_tr_b16 v[176:177], v18 offset:46592
    ds_read_b64_tr_b16 v[178:179], v19 offset:46592
    s_waitcnt lgkmcnt(14)
    v_mfma_f32_16x16x32_bf16 v[148:151], v[180:183], v[108:111], v[148:151]
    ds_read_b64_tr_b16 v[180:181], v22 offset:46592
    ds_read_b64_tr_b16 v[182:183], v23 offset:46592
    s_waitcnt lgkmcnt(14)
    v_mfma_f32_16x16x32_bf16 v[152:155], v[184:187], v[108:111], v[152:155]
    ds_read_b64_tr_b16 v[184:185], v26 offset:46592
    ds_read_b64_tr_b16 v[186:187], v27 offset:46592
    s_waitcnt lgkmcnt(14)
    v_mfma_f32_16x16x32_bf16 v[156:159], v[188:191], v[108:111], v[156:159]
    ds_read_b64_tr_b16 v[188:189], v30 offset:46592
    ds_read_b64_tr_b16 v[190:191], v31 offset:46592
    s_waitcnt lgkmcnt(14) vmcnt(3)
    v_mfma_f32_16x16x32_bf16 v[144:147], v[160:163], v[112:115], v[144:147]
    ds_read_b64_tr_b16 v[160:161], v16 offset:50176
    ds_read_b64_tr_b16 v[162:163], v17 offset:50176
    s_waitcnt lgkmcnt(14)
    v_mfma_f32_16x16x32_bf16 v[148:151], v[164:167], v[112:115], v[148:151]
    ds_read_b64_tr_b16 v[164:165], v20 offset:50176
    ds_read_b64_tr_b16 v[166:167], v21 offset:50176
    s_waitcnt lgkmcnt(14)
    v_mfma_f32_16x16x32_bf16 v[152:155], v[168:171], v[112:115], v[152:155]
    ds_read_b64_tr_b16 v[168:169], v24 offset:50176
    ds_read_b64_tr_b16 v[170:171], v25 offset:50176
    s_waitcnt lgkmcnt(14)
    v_mfma_f32_16x16x32_bf16 v[156:159], v[172:175], v[112:115], v[156:159]
    ds_read_b64_tr_b16 v[172:173], v28 offset:50176
    ds_read_b64_tr_b16 v[174:175], v29 offset:50176
    s_waitcnt lgkmcnt(14) vmcnt(2)
    v_mfma_f32_16x16x32_bf16 v[144:147], v[176:179], v[116:119], v[144:147]
    ds_read_b64_tr_b16 v[176:177], v18 offset:53760
    ds_read_b64_tr_b16 v[178:179], v19 offset:53760
    s_waitcnt lgkmcnt(14)
    v_mfma_f32_16x16x32_bf16 v[148:151], v[180:183], v[116:119], v[148:151]
    ds_read_b64_tr_b16 v[180:181], v22 offset:53760
    ds_read_b64_tr_b16 v[182:183], v23 offset:53760
    s_waitcnt lgkmcnt(14)
    v_mfma_f32_16x16x32_bf16 v[152:155], v[184:187], v[116:119], v[152:155]
    ds_read_b64_tr_b16 v[184:185], v26 offset:53760
    ds_read_b64_tr_b16 v[186:187], v27 offset:53760
    s_waitcnt lgkmcnt(14)
    v_mfma_f32_16x16x32_bf16 v[156:159], v[188:191], v[116:119], v[156:159]
    ds_read_b64_tr_b16 v[188:189], v30 offset:53760
    ds_read_b64_tr_b16 v[190:191], v31 offset:53760
    s_waitcnt lgkmcnt(14) vmcnt(1)
    v_mfma_f32_16x16x32_bf16 v[144:147], v[160:163], v[120:123], v[144:147]
    s_waitcnt lgkmcnt(12)
    v_mfma_f32_16x16x32_bf16 v[148:151], v[164:167], v[120:123], v[148:151]
    s_waitcnt lgkmcnt(10)
    v_mfma_f32_16x16x32_bf16 v[152:155], v[168:171], v[120:123], v[152:155]
    s_waitcnt lgkmcnt(8)
    v_mfma_f32_16x16x32_bf16 v[156:159], v[172:175], v[120:123], v[156:159]
    s_waitcnt lgkmcnt(6) vmcnt(0)
    v_mfma_f32_16x16x32_bf16 v[144:147], v[176:179], v[124:127], v[144:147]
    s_waitcnt lgkmcnt(4)
    v_mfma_f32_16x16x32_bf16 v[148:151], v[180:183], v[124:127], v[148:151]
    s_waitcnt lgkmcnt(2)
    v_mfma_f32_16x16x32_bf16 v[152:155], v[184:187], v[124:127], v[152:155]
    s_waitcnt lgkmcnt(0)
    v_mfma_f32_16x16x32_bf16 v[156:159], v[188:191], v[124:127], v[156:159]
    s_nop 1
    v_cvt_pk_bf16_f32 v16, v144, v145
    v_cvt_pk_bf16_f32 v17, v146, v147
    v_cvt_pk_bf16_f32 v18, v148, v149
    v_cvt_pk_bf16_f32 v19, v150, v151
    v_cvt_pk_bf16_f32 v20, v152, v153
    v_cvt_pk_bf16_f32 v21, v154, v155
    v_cvt_pk_bf16_f32 v22, v156, v157
    v_cvt_pk_bf16_f32 v23, v158, v159
    v_permlane16_swap_b32 v16, v18
    v_permlane16_swap_b32 v17, v19
    v_permlane16_swap_b32 v20, v22
    v_permlane16_swap_b32 v21, v23
    buffer_store_dwordx4 v[16:19], v33, s[48:51], s42 offen
    buffer_store_dwordx4 v[20:23], v33, s[48:51], s42 offen offset:64
L_FIN:
L_END:
    s_endpgm
.section .rodata,"a"
.p2align 6
.amdhsa_kernel concat_heads__softmax_full_mha__linear_attn_block__prompt_kernel
  .amdhsa_next_free_vgpr 256
  .amdhsa_next_free_sgpr 102
  .amdhsa_accum_offset 256
  .amdhsa_group_segment_fixed_size 0
  .amdhsa_kernarg_size 72
  .amdhsa_user_sgpr_count 2
  .amdhsa_user_sgpr_kernarg_segment_ptr 1
  .amdhsa_system_sgpr_workgroup_id_x 1
.end_amdhsa_kernel
```
